```python
import torch

def _softmax(x, axis=-1):
    return torch.softmax(x, dim=axis)
def _gelu(x):
    return torch.nn.functional.gelu(x, approximate="tanh")
def _silu(x):
    return torch.nn.functional.silu(x)
def _sigmoid(x):
    return torch.sigmoid(x)
def _layernorm(x, axis=-1, eps=1e-5):
    m = x.mean(dim=axis, keepdim=True)
    v = x.var(dim=axis, keepdim=True, unbiased=False)
    return (x - m) / torch.sqrt(v + eps)
def _scatter_add(tgt, idx, src, axis=0):
    return tgt.clone().index_add_(axis, idx, src)
def _segment_sum(src, seg, n):
    out = torch.zeros((n,) + src.shape[1:], dtype=src.dtype)
    return out.index_add_(0, seg, src)
def _pad(x, pw):
    flat = tuple(v for pair in reversed(pw) for v in pair)
    return torch.nn.functional.pad(x, flat)

kernel_name = 'concat_heads__ssm_conv_h3__softmax_full_mha__prompt'

def setup_inputs():

    _w = (lambda a: (lambda t: t.to(torch.bfloat16) if t.is_floating_point() else t)(torch.as_tensor(a)))
    def _A_setup():
        B, S, D = 1, 2048, 448
        ks = 4
        return {
            "q": _w((lambda *s: torch.randn(*s, dtype=torch.bfloat16) * 0.05)(B, S, D)),
            "k": _w((lambda *s: torch.randn(*s, dtype=torch.bfloat16) * 0.4)(B, S, D)),
            "v": _w((lambda *s: torch.randn(*s, dtype=torch.bfloat16) * 0.4)(B, S, D)),
            "shift_k": _w((lambda *s: torch.randn(*s, dtype=torch.bfloat16) * 0.4)(D, ks) * 0.5),
            "ssm_k": _w((lambda *s: torch.randn(*s, dtype=torch.bfloat16) * 0.8)(D, S) * (1.0 / S ** 0.5)),
            "ssm_D": _w((lambda *s: torch.randn(*s, dtype=torch.bfloat16) * 0.4)(D)),
        }
    _A_in = _A_setup()

    def _B_setup():
        B, S, D = 1, 2048, 448
        return {
            "x": _w((lambda *s: torch.randn(*s, dtype=torch.bfloat16) * 0.2)(B, S, D)),
            "wqkv": _w((lambda *s: torch.randn(*s, dtype=torch.bfloat16) * 0.2)(D, 3 * D)),
            "wo": _w((lambda *s: torch.randn(*s, dtype=torch.bfloat16) * 0.05)(D, D)),
        }
    _B_in = _B_setup()

    return {
        "A_q": _A_in["q"],
        "A_k": _A_in["k"],
        "A_v": _A_in["v"],
        "A_shift_k": _A_in["shift_k"],
        "A_ssm_k": _A_in["ssm_k"],
        "A_ssm_D": _A_in["ssm_D"],
        "B_x": _B_in["x"],
        "B_wqkv": _B_in["wqkv"],
        "B_wo": _B_in["wo"],
    }

def reference(A_q, A_k, A_v, A_shift_k, A_ssm_k, A_ssm_D, B_x, B_wqkv, B_wo):
    def _A_ref(q, k, v, shift_k, ssm_k, ssm_D):
        B, S, D = q.shape
        ks = shift_k.shape[-1]
        k_pad = _pad(k, ((0, 0), (ks - 1, 0), (0, 0)))
        k_shift = torch.zeros_like(k)
        for t in range(ks):
            k_shift = k_shift + k_pad[:, t:t + S, :] * shift_k[:, ks - 1 - t][None, None, :]
        kv = k_shift * v
        L = 2 * S
        kv_pad = _pad(kv, ((0, 0), (0, S), (0, 0)))
        kf_pad = _pad(ssm_k, ((0, 0), (0, S)))
        kv_f = (lambda x, axes=(-2,-1): torch.fft.rfft2(x.float(), dim=axes))(kv_pad[:, None, :, :], axes=(1, 2))
        kf_f = (lambda x, axes=(-2,-1): torch.fft.rfft2(x.float(), dim=axes))(kf_pad[:, None, :], axes=(1, 2))
        kf_f = (lambda x, *d: x.permute(*d))(kf_f, 1, 2, 0)
        y_f = kv_f * kf_f[None, :, :, :]
        y = (lambda x, s, axes=(-2,-1): torch.fft.irfft2(x, s=s, dim=axes).to(torch.bfloat16))(y_f, (1, L), axes=(1, 2))[:, 0, :S, :]
        y = y + kv * ssm_D[None, None, :]
        return q * y

    def _B_ref(x, wqkv, wo):
        B, S, D = x.shape
        H = 16; Dh = D // H
        qkv = (lambda x, *d: x.permute(*d))((x @ wqkv).reshape(B, S, 3, H, Dh), 2, 0, 3, 1, 4)
        q, k, v = qkv[0], qkv[1], qkv[2]
        scale = Dh ** -0.5
        scores = torch.einsum("bhqd,bhkd->bhqk", q, k) * scale
        p = _softmax(scores, axis=-1)
        o = torch.einsum("bhqk,bhkd->bhqd", p, v)
        return (lambda x, *d: x.permute(*d))(o, 0, 2, 1, 3).reshape(B, S, D) @ wo

    a = _A_ref(A_q, A_k, A_v, A_shift_k, A_ssm_k, A_ssm_D)
    b = _B_ref(B_x, B_wqkv, B_wo)
    return torch.concatenate([a, b], axis=-1)
```

```asm
; @launch grid=(256,1,1) block=(512,1,1) lds=160960
.amdgcn_target "amdgcn-amd-amdhsa--gfx950"
.text
.globl concat_heads__ssm_conv_h3__softmax_full_mha__prompt_kernel
.p2align 8
.type concat_heads__ssm_conv_h3__softmax_full_mha__prompt_kernel,@function
concat_heads__ssm_conv_h3__softmax_full_mha__prompt_kernel:
    s_load_dwordx2 s[4:5], s[0:1], 8
    s_load_dwordx2 s[8:9], s[0:1], 16
    s_load_dwordx2 s[16:17], s[0:1], 24
    s_load_dwordx2 s[24:25], s[0:1], 48
    s_load_dwordx2 s[28:29], s[0:1], 56
    s_load_dwordx2 s[20:21], s[0:1], 32
    s_load_dwordx2 s[12:13], s[0:1], 0
    s_load_dwordx2 s[32:33], s[0:1], 64
    s_load_dwordx2 s[36:37], s[0:1], 72
    s_load_dwordx2 s[44:45], s[0:1], 80
    s_load_dwordx2 s[40:41], s[0:1], 88
    s_load_dwordx2 s[62:63], s[0:1], 40
    s_cmp_ge_u32 s2, 256
    s_cbranch_scc1 L_end
    v_lshrrev_b32 v3, 6, v0
    v_and_b32 v1, 63, v0
    v_readfirstlane_b32 s3, v3
    v_lshlrev_b32 v2, 4, v1
    v_mov_b32 v4, 0
    v_mov_b32 v5, 0
    v_mov_b32 v6, 0
    v_mov_b32 v7, 0
    v_mov_b32 v3, 160912
    s_mov_b64 exec, 1
    ds_write_b128 v3, v[4:7]
    s_mov_b64 exec, -1
    s_mov_b32 s6, 1835008
    s_mov_b32 s7, 0x20000
    s_mov_b32 s10, 1835008
    s_mov_b32 s11, 0x20000
    s_mov_b32 s18, 3584
    s_mov_b32 s19, 0x20000
    s_mov_b32 s22, 1835008
    s_mov_b32 s23, 0x20000
    s_mov_b32 s26, 1835008
    s_mov_b32 s27, 0x20000
    s_mov_b32 s30, 1204224
    s_mov_b32 s31, 0x20000
    s_mov_b32 s14, 1835008
    s_mov_b32 s15, 0x20000
    s_mov_b32 s34, 401408
    s_mov_b32 s35, 0x20000
    s_mov_b32 s38, 3670016
    s_mov_b32 s39, 0x20000
    s_mov_b32 s46, 256
    s_mov_b32 s47, 0x20000
    s_mov_b32 s42, 12582912
    s_mov_b32 s43, 0x20000
    s_lshr_b32 s50, s2, 5
    s_min_u32 s50, s50, 6
    s_and_b32 s51, s2, 31
    s_cmp_ge_u32 s3, 4
    s_cbranch_scc1 L_roleA
    s_and_b32 s56, s2, 7
    s_lshr_b32 s57, s2, 3
    s_and_b32 s48, s56, 1
    s_lshl_b32 s48, s48, 3
    s_and_b32 s58, s57, 7
    s_add_u32 s48, s48, s58
    s_lshr_b32 s49, s56, 1
    s_lshl_b32 s49, s49, 2
    s_lshr_b32 s58, s57, 3
    s_add_u32 s49, s49, s58
    s_and_b32 s76, s57, 7
    s_lshl_b32 s76, s76, 0
    s_lshr_b32 s56, s57, 3
    s_lshl_b32 s56, s56, 1
    s_add_u32 s76, s76, s56
    s_cmp_ge_u32 s76, 7
    s_cselect_b32 s56, 7, 0
    s_sub_u32 s76, s76, s56
    s_cmp_ge_u32 s76, 7
    s_cselect_b32 s56, 7, 0
    s_sub_u32 s76, s76, s56
    s_cmp_ge_u32 s76, 7
    s_cselect_b32 s56, 7, 0
    s_sub_u32 s76, s76, s56
    v_lshrrev_b32 v3, 3, v1
    v_mul_u32_u24 v13, 896, v3
    v_and_b32 v14, 7, v1
    s_lshl_b32 s56, s49, 7
    s_lshl_b32 s57, s3, 5
    s_add_u32 s56, s56, s57
    s_mul_i32 s56, s56, 896
    v_lshrrev_b32 v3, 4, v1
    v_xor_b32 v3, v3, v14
    v_lshl_add_u32 v15, v3, 4, v13
    v_add_u32 v8, s56, v15
    v_xor_b32 v9, 64, v8
    s_mul_i32 s56, s48, 56
    v_lshrrev_b32 v3, 3, v1
    v_mul_u32_u24 v10, 2688, v3
    v_bfe_u32 v13, v1, 2, 1
    v_bfe_u32 v14, v1, 4, 1
    v_xor_b32 v13, v13, v14
    v_and_b32 v3, 3, v1
    v_mul_u32_u24 v14, 896, v13
    v_add3_u32 v10, v10, v14, s56
    v_add_u32 v14, 1, v3
    v_mul_u32_u24 v13, v13, v14
    v_lshlrev_b32 v14, 3, v3
    v_sub_u32 v14, v14, v13
    v_lshl_add_u32 v10, v14, 1, v10
    v_add_u32 v10, 896, v10
    v_lshrrev_b32 v13, 2, v1
    v_mul_u32_u24 v13, 2688, v13
    v_lshlrev_b32 v3, 4, v3
    v_add3_u32 v11, v13, v3, s56
    v_mov_b32 v247, 160916
    v_mov_b32 v248, 1
    s_mov_b32 s55, 0
    s_waitcnt lgkmcnt(0)
    s_barrier
    s_setprio 2
    s_lshl_b32 s82, s3, 12
    s_lshl_b32 s83, s3, 11
    s_add_u32 s83, s83, 16384
    s_mul_i32 s84, s3, 43008
    s_mov_b32 s78, 0
    s_mov_b32 s80, s76
    s_lshl_b32 s85, s76, 7
    s_mul_i32 s86, s76, 172032
    s_add_u32 s86, s86, s84
    s_add_u32 s56, s78, s82
    s_add_u32 s57, s78, s83
    s_mov_b32 m0, s56
    s_nop 0
    buffer_load_dwordx4 v8, s[24:27], s85 offen lds
    s_add_u32 m0, s56, 1024
    s_add_u32 s85, s85, 7168
    buffer_load_dwordx4 v9, s[24:27], s85 offen lds
    s_add_u32 m0, s56, 2048
    s_add_u32 s85, s85, 7168
    buffer_load_dwordx4 v8, s[24:27], s85 offen lds
    s_add_u32 m0, s56, 3072
    s_add_u32 s85, s85, 7168
    buffer_load_dwordx4 v9, s[24:27], s85 offen lds
    s_mov_b32 m0, s57
    s_nop 0
    buffer_load_dwordx4 v10, s[28:31], s86 offen lds
    s_add_u32 m0, s57, 1024
    s_add_u32 s86, s86, 21504
    buffer_load_dwordx4 v10, s[28:31], s86 offen lds
    s_add_u32 s76, s76, 1
    s_cmp_eq_u32 s76, 7
    s_cselect_b32 s76, 0, s76
    s_add_u32 s78, s78, 24576
    s_cmp_eq_u32 s78, 98304
    s_cselect_b32 s78, 0, s78
    s_lshl_b32 s85, s76, 7
    s_mul_i32 s86, s76, 172032
    s_add_u32 s86, s86, s84
    s_add_u32 s56, s78, s82
    s_add_u32 s57, s78, s83
    s_mov_b32 m0, s56
    s_nop 0
    buffer_load_dwordx4 v8, s[24:27], s85 offen lds
    s_add_u32 m0, s56, 1024
    s_add_u32 s85, s85, 7168
    buffer_load_dwordx4 v9, s[24:27], s85 offen lds
    s_add_u32 m0, s56, 2048
    s_add_u32 s85, s85, 7168
    buffer_load_dwordx4 v8, s[24:27], s85 offen lds
    s_add_u32 m0, s56, 3072
    s_add_u32 s85, s85, 7168
    buffer_load_dwordx4 v9, s[24:27], s85 offen lds
    s_mov_b32 m0, s57
    s_nop 0
    buffer_load_dwordx4 v10, s[28:31], s86 offen lds
    s_add_u32 m0, s57, 1024
    s_add_u32 s86, s86, 21504
    buffer_load_dwordx4 v10, s[28:31], s86 offen lds
    s_add_u32 s76, s76, 1
    s_cmp_eq_u32 s76, 7
    s_cselect_b32 s76, 0, s76
    s_add_u32 s78, s78, 24576
    s_cmp_eq_u32 s78, 98304
    s_cselect_b32 s78, 0, s78
    v_mov_b32 v242, 0
    buffer_load_dwordx2 v[240:241], v242, s[44:47], 0 offen sc1
    v_lshrrev_b32 v3, 5, v1
    v_lshlrev_b32 v4, 3, v3
    v_bfe_u32 v13, v1, 2, 2
    v_add_u32 v4, v4, v13
    v_bfe_u32 v5, v1, 4, 1
    v_and_b32 v6, 3, v1
    v_lshlrev_b32 v14, 6, v4
    v_lshl_add_u32 v14, v5, 5, v14
    v_lshl_add_u32 v14, v6, 3, v14
    v_add_u32 v220, 98304, v14
    v_lshlrev_b32 v14, 7, v4
    v_lshl_add_u32 v14, v5, 5, v14
    v_add_u32 v14, 16384, v14
    v_bfe_u32 v15, v13, 1, 1
    v_lshlrev_b32 v7, 6, v15
    v_add_u32 v7, v7, v14
    v_lshl_add_u32 v208, v6, 3, v7
    v_xor_b32 v15, 1, v15
    v_lshlrev_b32 v7, 6, v15
    v_add_u32 v7, v7, v14
    v_and_b32 v15, 1, v6
    v_lshl_add_u32 v7, v15, 4, v7
    v_lshrrev_b32 v15, 1, v6
    v_lshl_add_u32 v209, v15, 3, v7
    v_and_b32 v13, 31, v1
    v_bfe_u32 v14, v1, 1, 3
    v_xor_b32 v14, v14, v3
    v_lshlrev_b32 v14, 4, v14
    v_lshl_add_u32 v14, v13, 7, v14
    s_lshl_b32 s56, s3, 12
    v_add_u32 v212, s56, v14
    v_xor_b32 v213, 32, v212
    v_xor_b32 v214, 64, v212
    v_xor_b32 v215, 96, v212
    s_mov_b32 s79, 0
    s_waitcnt vmcnt(7)
    s_add_u32 s55, s55, 4
    s_mov_b64 exec, 1
    ds_add_u32 v247, v248
    s_mov_b64 exec, -1
    s_mov_b32 s97, 0x100000
L_sw1:
    ds_read_b32 v249, v247
    s_waitcnt lgkmcnt(0)
    v_readfirstlane_b32 s95, v249
    s_cmp_ge_u32 s95, s55
    s_cbranch_scc1 L_swd1
    s_sub_u32 s97, s97, 1
    s_cbranch_scc0 L_sw1
L_swd1:
    v_add_u32 v216, s79, v212
    v_add_u32 v217, s79, v213
    v_add_u32 v218, s79, v214
    v_add_u32 v219, s79, v215
    v_add_u32 v210, s79, v208
    v_add_u32 v211, s79, v209
    s_add_u32 s79, s79, 24576
    s_cmp_eq_u32 s79, 98304
    s_cselect_b32 s79, 0, s79
    ds_read_b128 v[16:19], v216
    ds_read_b64_tr_b16 v[176:177], v210 offset:0
    ds_read_b64_tr_b16 v[178:179], v210 offset:512
    ds_read_b64_tr_b16 v[180:181], v211 offset:0
    ds_read_b64_tr_b16 v[182:183], v211 offset:512
    ds_read_b128 v[20:23], v217
    ds_read_b64_tr_b16 v[184:185], v210 offset:2048
    ds_read_b64_tr_b16 v[186:187], v210 offset:2560
    ds_read_b64_tr_b16 v[188:189], v211 offset:2048
    ds_read_b64_tr_b16 v[190:191], v211 offset:2560
    s_waitcnt lgkmcnt(5)
    v_mfma_f32_32x32x16_bf16 v[128:143], v[176:179], v[16:19], 0
    v_mfma_f32_32x32x16_bf16 v[144:159], v[16:19], v[180:183], 0
    s_lshl_b32 s85, s76, 7
    s_mul_i32 s86, s76, 172032
    s_add_u32 s86, s86, s84
    s_add_u32 s56, s78, s82
    s_add_u32 s57, s78, s83
    s_mov_b32 m0, s56
    s_nop 0
    buffer_load_dwordx4 v8, s[24:27], s85 offen lds
    s_add_u32 m0, s56, 1024
    s_add_u32 s85, s85, 7168
    buffer_load_dwordx4 v9, s[24:27], s85 offen lds
    s_add_u32 m0, s56, 2048
    s_add_u32 s85, s85, 7168
    buffer_load_dwordx4 v8, s[24:27], s85 offen lds
    ds_read_b128 v[24:27], v218
    ds_read_b64_tr_b16 v[176:177], v210 offset:4096
    ds_read_b64_tr_b16 v[178:179], v210 offset:4608
    ds_read_b64_tr_b16 v[180:181], v211 offset:4096
    ds_read_b64_tr_b16 v[182:183], v211 offset:4608
    s_waitcnt lgkmcnt(5)
    v_mfma_f32_32x32x16_bf16 v[128:143], v[184:187], v[20:23], v[128:143]
    v_mfma_f32_32x32x16_bf16 v[144:159], v[20:23], v[188:191], v[144:159]
    s_add_u32 m0, s56, 3072
    s_add_u32 s85, s85, 7168
    buffer_load_dwordx4 v9, s[24:27], s85 offen lds
    s_mov_b32 m0, s57
    s_nop 0
    buffer_load_dwordx4 v10, s[28:31], s86 offen lds
    s_add_u32 m0, s57, 1024
    s_add_u32 s86, s86, 21504
    buffer_load_dwordx4 v10, s[28:31], s86 offen lds
    s_add_u32 s76, s76, 1
    s_cmp_eq_u32 s76, 7
    s_cselect_b32 s76, 0, s76
    s_add_u32 s78, s78, 24576
    s_cmp_eq_u32 s78, 98304
    s_cselect_b32 s78, 0, s78
    s_waitcnt vmcnt(7)
    s_add_u32 s55, s55, 4
    s_mov_b64 exec, 1
    ds_add_u32 v247, v248
    s_mov_b64 exec, -1
    ds_read_b128 v[28:31], v219
    ds_read_b64_tr_b16 v[184:185], v210 offset:6144
    ds_read_b64_tr_b16 v[186:187], v210 offset:6656
    ds_read_b64_tr_b16 v[188:189], v211 offset:6144
    ds_read_b64_tr_b16 v[190:191], v211 offset:6656
    s_waitcnt lgkmcnt(5)
    v_mfma_f32_32x32x16_bf16 v[128:143], v[176:179], v[24:27], v[128:143]
    v_mfma_f32_32x32x16_bf16 v[144:159], v[24:27], v[180:183], v[144:159]
    s_mov_b32 s97, 0x100000
L_sw2:
    ds_read_b32 v249, v247
    s_waitcnt lgkmcnt(0)
    v_readfirstlane_b32 s95, v249
    s_cmp_ge_u32 s95, s55
    s_cbranch_scc1 L_swd2
    s_sub_u32 s97, s97, 1
    s_cbranch_scc0 L_sw2
L_swd2:
    v_add_u32 v216, s79, v212
    v_add_u32 v217, s79, v213
    v_add_u32 v218, s79, v214
    v_add_u32 v219, s79, v215
    v_add_u32 v210, s79, v208
    v_add_u32 v211, s79, v209
    s_add_u32 s79, s79, 24576
    s_cmp_eq_u32 s79, 98304
    s_cselect_b32 s79, 0, s79
    ds_read_b128 v[32:35], v216
    ds_read_b64_tr_b16 v[176:177], v210 offset:0
    ds_read_b64_tr_b16 v[178:179], v210 offset:512
    ds_read_b64_tr_b16 v[180:181], v211 offset:0
    ds_read_b64_tr_b16 v[182:183], v211 offset:512
    v_mfma_f32_32x32x16_bf16 v[128:143], v[184:187], v[28:31], v[128:143]
    v_mfma_f32_32x32x16_bf16 v[144:159], v[28:31], v[188:191], v[144:159]
    ds_read_b128 v[36:39], v217
    ds_read_b64_tr_b16 v[184:185], v210 offset:2048
    ds_read_b64_tr_b16 v[186:187], v210 offset:2560
    ds_read_b64_tr_b16 v[188:189], v211 offset:2048
    ds_read_b64_tr_b16 v[190:191], v211 offset:2560
    s_waitcnt lgkmcnt(5)
    v_mfma_f32_32x32x16_bf16 v[128:143], v[176:179], v[32:35], v[128:143]
    v_mfma_f32_32x32x16_bf16 v[144:159], v[32:35], v[180:183], v[144:159]
    s_lshl_b32 s85, s76, 7
    s_mul_i32 s86, s76, 172032
    s_add_u32 s86, s86, s84
    s_add_u32 s56, s78, s82
    s_add_u32 s57, s78, s83
    s_mov_b32 m0, s56
    s_nop 0
    buffer_load_dwordx4 v8, s[24:27], s85 offen lds
    s_add_u32 m0, s56, 1024
    s_add_u32 s85, s85, 7168
    buffer_load_dwordx4 v9, s[24:27], s85 offen lds
    s_add_u32 m0, s56, 2048
    s_add_u32 s85, s85, 7168
    buffer_load_dwordx4 v8, s[24:27], s85 offen lds
    ds_read_b128 v[40:43], v218
    ds_read_b64_tr_b16 v[176:177], v210 offset:4096
    ds_read_b64_tr_b16 v[178:179], v210 offset:4608
    ds_read_b64_tr_b16 v[180:181], v211 offset:4096
    ds_read_b64_tr_b16 v[182:183], v211 offset:4608
    s_waitcnt lgkmcnt(5)
    v_mfma_f32_32x32x16_bf16 v[128:143], v[184:187], v[36:39], v[128:143]
    v_mfma_f32_32x32x16_bf16 v[144:159], v[36:39], v[188:191], v[144:159]
    s_add_u32 m0, s56, 3072
    s_add_u32 s85, s85, 7168
    buffer_load_dwordx4 v9, s[24:27], s85 offen lds
    s_mov_b32 m0, s57
    s_nop 0
    buffer_load_dwordx4 v10, s[28:31], s86 offen lds
    s_add_u32 m0, s57, 1024
    s_add_u32 s86, s86, 21504
    buffer_load_dwordx4 v10, s[28:31], s86 offen lds
    s_add_u32 s76, s76, 1
    s_cmp_eq_u32 s76, 7
    s_cselect_b32 s76, 0, s76
    s_add_u32 s78, s78, 24576
    s_cmp_eq_u32 s78, 98304
    s_cselect_b32 s78, 0, s78
    s_waitcnt vmcnt(6)
    s_add_u32 s55, s55, 4
    s_mov_b64 exec, 1
    ds_add_u32 v247, v248
    s_mov_b64 exec, -1
    ds_read_b128 v[44:47], v219
    ds_read_b64_tr_b16 v[184:185], v210 offset:6144
    ds_read_b64_tr_b16 v[186:187], v210 offset:6656
    ds_read_b64_tr_b16 v[188:189], v211 offset:6144
    ds_read_b64_tr_b16 v[190:191], v211 offset:6656
    s_waitcnt lgkmcnt(5)
    v_mfma_f32_32x32x16_bf16 v[128:143], v[176:179], v[40:43], v[128:143]
    v_mfma_f32_32x32x16_bf16 v[144:159], v[40:43], v[180:183], v[144:159]
    s_mov_b32 s97, 0x100000
L_sw3:
    ds_read_b32 v249, v247
    s_waitcnt lgkmcnt(0)
    v_readfirstlane_b32 s95, v249
    s_cmp_ge_u32 s95, s55
    s_cbranch_scc1 L_swd3
    s_sub_u32 s97, s97, 1
    s_cbranch_scc0 L_sw3
L_swd3:
    v_add_u32 v216, s79, v212
    v_add_u32 v217, s79, v213
    v_add_u32 v218, s79, v214
    v_add_u32 v219, s79, v215
    v_add_u32 v210, s79, v208
    v_add_u32 v211, s79, v209
    s_add_u32 s79, s79, 24576
    s_cmp_eq_u32 s79, 98304
    s_cselect_b32 s79, 0, s79
    ds_read_b128 v[48:51], v216
    ds_read_b64_tr_b16 v[176:177], v210 offset:0
    ds_read_b64_tr_b16 v[178:179], v210 offset:512
    ds_read_b64_tr_b16 v[180:181], v211 offset:0
    ds_read_b64_tr_b16 v[182:183], v211 offset:512
    v_mfma_f32_32x32x16_bf16 v[128:143], v[184:187], v[44:47], v[128:143]
    v_mfma_f32_32x32x16_bf16 v[144:159], v[44:47], v[188:191], v[144:159]
    ds_read_b128 v[52:55], v217
    ds_read_b64_tr_b16 v[184:185], v210 offset:2048
    ds_read_b64_tr_b16 v[186:187], v210 offset:2560
    ds_read_b64_tr_b16 v[188:189], v211 offset:2048
    ds_read_b64_tr_b16 v[190:191], v211 offset:2560
    s_waitcnt lgkmcnt(5)
    v_mfma_f32_32x32x16_bf16 v[128:143], v[176:179], v[48:51], v[128:143]
    v_mfma_f32_32x32x16_bf16 v[144:159], v[48:51], v[180:183], v[144:159]
    s_lshl_b32 s85, s76, 7
    s_mul_i32 s86, s76, 172032
    s_add_u32 s86, s86, s84
    s_add_u32 s56, s78, s82
    s_add_u32 s57, s78, s83
    s_mov_b32 m0, s56
    s_nop 0
    buffer_load_dwordx4 v8, s[24:27], s85 offen lds
    s_add_u32 m0, s56, 1024
    s_add_u32 s85, s85, 7168
    buffer_load_dwordx4 v9, s[24:27], s85 offen lds
    s_add_u32 m0, s56, 2048
    s_add_u32 s85, s85, 7168
    buffer_load_dwordx4 v8, s[24:27], s85 offen lds
    ds_read_b128 v[56:59], v218
    ds_read_b64_tr_b16 v[176:177], v210 offset:4096
    ds_read_b64_tr_b16 v[178:179], v210 offset:4608
    ds_read_b64_tr_b16 v[180:181], v211 offset:4096
    ds_read_b64_tr_b16 v[182:183], v211 offset:4608
    s_waitcnt lgkmcnt(5)
    v_mfma_f32_32x32x16_bf16 v[128:143], v[184:187], v[52:55], v[128:143]
    v_mfma_f32_32x32x16_bf16 v[144:159], v[52:55], v[188:191], v[144:159]
    s_add_u32 m0, s56, 3072
    s_add_u32 s85, s85, 7168
    buffer_load_dwordx4 v9, s[24:27], s85 offen lds
    s_mov_b32 m0, s57
    s_nop 0
    buffer_load_dwordx4 v10, s[28:31], s86 offen lds
    s_add_u32 m0, s57, 1024
    s_add_u32 s86, s86, 21504
    buffer_load_dwordx4 v10, s[28:31], s86 offen lds
    s_add_u32 s76, s76, 1
    s_cmp_eq_u32 s76, 7
    s_cselect_b32 s76, 0, s76
    s_add_u32 s78, s78, 24576
    s_cmp_eq_u32 s78, 98304
    s_cselect_b32 s78, 0, s78
    s_waitcnt vmcnt(6)
    s_add_u32 s55, s55, 4
    s_mov_b64 exec, 1
    ds_add_u32 v247, v248
    s_mov_b64 exec, -1
    ds_read_b128 v[60:63], v219
    ds_read_b64_tr_b16 v[184:185], v210 offset:6144
    ds_read_b64_tr_b16 v[186:187], v210 offset:6656
    ds_read_b64_tr_b16 v[188:189], v211 offset:6144
    ds_read_b64_tr_b16 v[190:191], v211 offset:6656
    s_waitcnt lgkmcnt(5)
    v_mfma_f32_32x32x16_bf16 v[128:143], v[176:179], v[56:59], v[128:143]
    v_mfma_f32_32x32x16_bf16 v[144:159], v[56:59], v[180:183], v[144:159]
    s_mov_b32 s97, 0x100000
L_sw4:
    ds_read_b32 v249, v247
    s_waitcnt lgkmcnt(0)
    v_readfirstlane_b32 s95, v249
    s_cmp_ge_u32 s95, s55
    s_cbranch_scc1 L_swd4
    s_sub_u32 s97, s97, 1
    s_cbranch_scc0 L_sw4
L_swd4:
    v_add_u32 v216, s79, v212
    v_add_u32 v217, s79, v213
    v_add_u32 v218, s79, v214
    v_add_u32 v219, s79, v215
    v_add_u32 v210, s79, v208
    v_add_u32 v211, s79, v209
    s_add_u32 s79, s79, 24576
    s_cmp_eq_u32 s79, 98304
    s_cselect_b32 s79, 0, s79
    ds_read_b128 v[64:67], v216
    ds_read_b64_tr_b16 v[176:177], v210 offset:0
    ds_read_b64_tr_b16 v[178:179], v210 offset:512
    ds_read_b64_tr_b16 v[180:181], v211 offset:0
    ds_read_b64_tr_b16 v[182:183], v211 offset:512
    v_mfma_f32_32x32x16_bf16 v[128:143], v[184:187], v[60:63], v[128:143]
    v_mfma_f32_32x32x16_bf16 v[144:159], v[60:63], v[188:191], v[144:159]
    ds_read_b128 v[68:71], v217
    ds_read_b64_tr_b16 v[184:185], v210 offset:2048
    ds_read_b64_tr_b16 v[186:187], v210 offset:2560
    ds_read_b64_tr_b16 v[188:189], v211 offset:2048
    ds_read_b64_tr_b16 v[190:191], v211 offset:2560
    s_waitcnt lgkmcnt(5)
    v_mfma_f32_32x32x16_bf16 v[128:143], v[176:179], v[64:67], v[128:143]
    v_mfma_f32_32x32x16_bf16 v[144:159], v[64:67], v[180:183], v[144:159]
    s_lshl_b32 s85, s76, 7
    s_mul_i32 s86, s76, 172032
    s_add_u32 s86, s86, s84
    s_add_u32 s56, s78, s82
    s_add_u32 s57, s78, s83
    s_mov_b32 m0, s56
    s_nop 0
    buffer_load_dwordx4 v8, s[24:27], s85 offen lds
    s_add_u32 m0, s56, 1024
    s_add_u32 s85, s85, 7168
    buffer_load_dwordx4 v9, s[24:27], s85 offen lds
    s_add_u32 m0, s56, 2048
    s_add_u32 s85, s85, 7168
    buffer_load_dwordx4 v8, s[24:27], s85 offen lds
    ds_read_b128 v[72:75], v218
    ds_read_b64_tr_b16 v[176:177], v210 offset:4096
    ds_read_b64_tr_b16 v[178:179], v210 offset:4608
    ds_read_b64_tr_b16 v[180:181], v211 offset:4096
    ds_read_b64_tr_b16 v[182:183], v211 offset:4608
    s_waitcnt lgkmcnt(5)
    v_mfma_f32_32x32x16_bf16 v[128:143], v[184:187], v[68:71], v[128:143]
    v_mfma_f32_32x32x16_bf16 v[144:159], v[68:71], v[188:191], v[144:159]
    s_add_u32 m0, s56, 3072
    s_add_u32 s85, s85, 7168
    buffer_load_dwordx4 v9, s[24:27], s85 offen lds
    s_mov_b32 m0, s57
    s_nop 0
    buffer_load_dwordx4 v10, s[28:31], s86 offen lds
    s_add_u32 m0, s57, 1024
    s_add_u32 s86, s86, 21504
    buffer_load_dwordx4 v10, s[28:31], s86 offen lds
    s_add_u32 s76, s76, 1
    s_cmp_eq_u32 s76, 7
    s_cselect_b32 s76, 0, s76
    s_add_u32 s78, s78, 24576
    s_cmp_eq_u32 s78, 98304
    s_cselect_b32 s78, 0, s78
    s_waitcnt vmcnt(6)
    s_add_u32 s55, s55, 4
    s_mov_b64 exec, 1
    ds_add_u32 v247, v248
    s_mov_b64 exec, -1
    ds_read_b128 v[76:79], v219
    ds_read_b64_tr_b16 v[184:185], v210 offset:6144
    ds_read_b64_tr_b16 v[186:187], v210 offset:6656
    ds_read_b64_tr_b16 v[188:189], v211 offset:6144
    ds_read_b64_tr_b16 v[190:191], v211 offset:6656
    s_waitcnt lgkmcnt(5)
    v_mfma_f32_32x32x16_bf16 v[128:143], v[176:179], v[72:75], v[128:143]
    v_mfma_f32_32x32x16_bf16 v[144:159], v[72:75], v[180:183], v[144:159]
    s_mov_b32 s97, 0x100000
L_sw5:
    ds_read_b32 v249, v247
    s_waitcnt lgkmcnt(0)
    v_readfirstlane_b32 s95, v249
    s_cmp_ge_u32 s95, s55
    s_cbranch_scc1 L_swd5
    s_sub_u32 s97, s97, 1
    s_cbranch_scc0 L_sw5
L_swd5:
    v_add_u32 v216, s79, v212
    v_add_u32 v217, s79, v213
    v_add_u32 v218, s79, v214
    v_add_u32 v219, s79, v215
    v_add_u32 v210, s79, v208
    v_add_u32 v211, s79, v209
    s_add_u32 s79, s79, 24576
    s_cmp_eq_u32 s79, 98304
    s_cselect_b32 s79, 0, s79
    ds_read_b128 v[80:83], v216
    ds_read_b64_tr_b16 v[176:177], v210 offset:0
    ds_read_b64_tr_b16 v[178:179], v210 offset:512
    ds_read_b64_tr_b16 v[180:181], v211 offset:0
    ds_read_b64_tr_b16 v[182:183], v211 offset:512
    v_mfma_f32_32x32x16_bf16 v[128:143], v[184:187], v[76:79], v[128:143]
    v_mfma_f32_32x32x16_bf16 v[144:159], v[76:79], v[188:191], v[144:159]
    ds_read_b128 v[84:87], v217
    ds_read_b64_tr_b16 v[184:185], v210 offset:2048
    ds_read_b64_tr_b16 v[186:187], v210 offset:2560
    ds_read_b64_tr_b16 v[188:189], v211 offset:2048
    ds_read_b64_tr_b16 v[190:191], v211 offset:2560
    s_waitcnt lgkmcnt(5)
    v_mfma_f32_32x32x16_bf16 v[128:143], v[176:179], v[80:83], v[128:143]
    v_mfma_f32_32x32x16_bf16 v[144:159], v[80:83], v[180:183], v[144:159]
    s_lshl_b32 s85, s76, 7
    s_mul_i32 s86, s76, 172032
    s_add_u32 s86, s86, s84
    s_add_u32 s56, s78, s82
    s_add_u32 s57, s78, s83
    s_mov_b32 m0, s56
    s_nop 0
    buffer_load_dwordx4 v8, s[24:27], s85 offen lds
    s_add_u32 m0, s56, 1024
    s_add_u32 s85, s85, 7168
    buffer_load_dwordx4 v9, s[24:27], s85 offen lds
    s_add_u32 m0, s56, 2048
    s_add_u32 s85, s85, 7168
    buffer_load_dwordx4 v8, s[24:27], s85 offen lds
    ds_read_b128 v[88:91], v218
    ds_read_b64_tr_b16 v[176:177], v210 offset:4096
    ds_read_b64_tr_b16 v[178:179], v210 offset:4608
    ds_read_b64_tr_b16 v[180:181], v211 offset:4096
    ds_read_b64_tr_b16 v[182:183], v211 offset:4608
    s_waitcnt lgkmcnt(5)
    v_mfma_f32_32x32x16_bf16 v[128:143], v[184:187], v[84:87], v[128:143]
    v_mfma_f32_32x32x16_bf16 v[144:159], v[84:87], v[188:191], v[144:159]
    s_add_u32 m0, s56, 3072
    s_add_u32 s85, s85, 7168
    buffer_load_dwordx4 v9, s[24:27], s85 offen lds
    s_mov_b32 m0, s57
    s_nop 0
    buffer_load_dwordx4 v10, s[28:31], s86 offen lds
    s_add_u32 m0, s57, 1024
    s_add_u32 s86, s86, 21504
    buffer_load_dwordx4 v10, s[28:31], s86 offen lds
    s_add_u32 s76, s76, 1
    s_cmp_eq_u32 s76, 7
    s_cselect_b32 s76, 0, s76
    s_add_u32 s78, s78, 24576
    s_cmp_eq_u32 s78, 98304
    s_cselect_b32 s78, 0, s78
    s_waitcnt vmcnt(6)
    s_add_u32 s55, s55, 4
    s_mov_b64 exec, 1
    ds_add_u32 v247, v248
    s_mov_b64 exec, -1
    ds_read_b128 v[92:95], v219
    ds_read_b64_tr_b16 v[184:185], v210 offset:6144
    ds_read_b64_tr_b16 v[186:187], v210 offset:6656
    ds_read_b64_tr_b16 v[188:189], v211 offset:6144
    ds_read_b64_tr_b16 v[190:191], v211 offset:6656
    s_waitcnt lgkmcnt(5)
    v_mfma_f32_32x32x16_bf16 v[128:143], v[176:179], v[88:91], v[128:143]
    v_mfma_f32_32x32x16_bf16 v[144:159], v[88:91], v[180:183], v[144:159]
    s_mov_b32 s97, 0x100000
L_sw6:
    ds_read_b32 v249, v247
    s_waitcnt lgkmcnt(0)
    v_readfirstlane_b32 s95, v249
    s_cmp_ge_u32 s95, s55
    s_cbranch_scc1 L_swd6
    s_sub_u32 s97, s97, 1
    s_cbranch_scc0 L_sw6
L_swd6:
    v_add_u32 v216, s79, v212
    v_add_u32 v217, s79, v213
    v_add_u32 v218, s79, v214
    v_add_u32 v219, s79, v215
    v_add_u32 v210, s79, v208
    v_add_u32 v211, s79, v209
    s_add_u32 s79, s79, 24576
    s_cmp_eq_u32 s79, 98304
    s_cselect_b32 s79, 0, s79
    ds_read_b128 v[96:99], v216
    ds_read_b64_tr_b16 v[176:177], v210 offset:0
    ds_read_b64_tr_b16 v[178:179], v210 offset:512
    ds_read_b64_tr_b16 v[180:181], v211 offset:0
    ds_read_b64_tr_b16 v[182:183], v211 offset:512
    v_mfma_f32_32x32x16_bf16 v[128:143], v[184:187], v[92:95], v[128:143]
    v_mfma_f32_32x32x16_bf16 v[144:159], v[92:95], v[188:191], v[144:159]
    ds_read_b128 v[100:103], v217
    ds_read_b64_tr_b16 v[184:185], v210 offset:2048
    ds_read_b64_tr_b16 v[186:187], v210 offset:2560
    ds_read_b64_tr_b16 v[188:189], v211 offset:2048
    ds_read_b64_tr_b16 v[190:191], v211 offset:2560
    s_waitcnt lgkmcnt(5)
    v_mfma_f32_32x32x16_bf16 v[128:143], v[176:179], v[96:99], v[128:143]
    v_mfma_f32_32x32x16_bf16 v[144:159], v[96:99], v[180:183], v[144:159]
    s_mov_b32 s76, s80
    s_mul_i32 s86, s76, 172032
    s_add_u32 s86, s86, s84
    s_lshl_b32 s56, s3, 10
    s_add_u32 m0, s56, 98304
    s_add_u32 s76, s76, 1
    s_cmp_eq_u32 s76, 7
    s_cselect_b32 s76, 0, s76
    buffer_load_dwordx4 v11, s[28:31], s86 offen lds
    s_mul_i32 s86, s76, 172032
    s_add_u32 s86, s86, s84
    s_lshl_b32 s56, s3, 10
    s_add_u32 m0, s56, 102400
    s_add_u32 s76, s76, 1
    s_cmp_eq_u32 s76, 7
    s_cselect_b32 s76, 0, s76
    buffer_load_dwordx4 v11, s[28:31], s86 offen lds
    s_mul_i32 s86, s76, 172032
    s_add_u32 s86, s86, s84
    s_lshl_b32 s56, s3, 10
    s_add_u32 m0, s56, 106496
    s_add_u32 s76, s76, 1
    s_cmp_eq_u32 s76, 7
    s_cselect_b32 s76, 0, s76
    buffer_load_dwordx4 v11, s[28:31], s86 offen lds
    s_mul_i32 s86, s76, 172032
    s_add_u32 s86, s86, s84
    s_lshl_b32 s56, s3, 10
    s_add_u32 m0, s56, 110592
    s_add_u32 s76, s76, 1
    s_cmp_eq_u32 s76, 7
    s_cselect_b32 s76, 0, s76
    buffer_load_dwordx4 v11, s[28:31], s86 offen lds
    ds_read_b128 v[104:107], v218
    ds_read_b64_tr_b16 v[176:177], v210 offset:4096
    ds_read_b64_tr_b16 v[178:179], v210 offset:4608
    ds_read_b64_tr_b16 v[180:181], v211 offset:4096
    ds_read_b64_tr_b16 v[182:183], v211 offset:4608
    s_waitcnt lgkmcnt(5)
    v_mfma_f32_32x32x16_bf16 v[128:143], v[184:187], v[100:103], v[128:143]
    v_mfma_f32_32x32x16_bf16 v[144:159], v[100:103], v[188:191], v[144:159]
    s_mul_i32 s86, s76, 172032
    s_add_u32 s86, s86, s84
    s_lshl_b32 s56, s3, 10
    s_add_u32 m0, s56, 114688
    s_add_u32 s76, s76, 1
    s_cmp_eq_u32 s76, 7
    s_cselect_b32 s76, 0, s76
    buffer_load_dwordx4 v11, s[28:31], s86 offen lds
    s_mul_i32 s86, s76, 172032
    s_add_u32 s86, s86, s84
    s_lshl_b32 s56, s3, 10
    s_add_u32 m0, s56, 118784
    s_add_u32 s76, s76, 1
    s_cmp_eq_u32 s76, 7
    s_cselect_b32 s76, 0, s76
    buffer_load_dwordx4 v11, s[28:31], s86 offen lds
    s_mul_i32 s86, s76, 172032
    s_add_u32 s86, s86, s84
    s_lshl_b32 s56, s3, 10
    s_add_u32 m0, s56, 122880
    s_add_u32 s76, s76, 1
    s_cmp_eq_u32 s76, 7
    s_cselect_b32 s76, 0, s76
    buffer_load_dwordx4 v11, s[28:31], s86 offen lds
    s_waitcnt vmcnt(7)
    s_add_u32 s55, s55, 4
    s_mov_b64 exec, 1
    ds_add_u32 v247, v248
    s_mov_b64 exec, -1
    ds_read_b128 v[108:111], v219
    ds_read_b64_tr_b16 v[184:185], v210 offset:6144
    ds_read_b64_tr_b16 v[186:187], v210 offset:6656
    ds_read_b64_tr_b16 v[188:189], v211 offset:6144
    ds_read_b64_tr_b16 v[190:191], v211 offset:6656
    s_waitcnt lgkmcnt(5)
    v_mfma_f32_32x32x16_bf16 v[128:143], v[176:179], v[104:107], v[128:143]
    v_mfma_f32_32x32x16_bf16 v[144:159], v[104:107], v[180:183], v[144:159]
    s_mov_b32 s97, 0x100000
L_sw7:
    ds_read_b32 v249, v247
    s_waitcnt lgkmcnt(0)
    v_readfirstlane_b32 s95, v249
    s_cmp_ge_u32 s95, s55
    s_cbranch_scc1 L_swd7
    s_sub_u32 s97, s97, 1
    s_cbranch_scc0 L_sw7
L_swd7:
    v_add_u32 v216, s79, v212
    v_add_u32 v217, s79, v213
    v_add_u32 v218, s79, v214
    v_add_u32 v219, s79, v215
    v_add_u32 v210, s79, v208
    v_add_u32 v211, s79, v209
    s_add_u32 s79, s79, 24576
    s_cmp_eq_u32 s79, 98304
    s_cselect_b32 s79, 0, s79
    ds_read_b128 v[112:115], v216
    ds_read_b64_tr_b16 v[176:177], v210 offset:0
    ds_read_b64_tr_b16 v[178:179], v210 offset:512
    ds_read_b64_tr_b16 v[180:181], v211 offset:0
    ds_read_b64_tr_b16 v[182:183], v211 offset:512
    v_mfma_f32_32x32x16_bf16 v[128:143], v[184:187], v[108:111], v[128:143]
    v_mfma_f32_32x32x16_bf16 v[144:159], v[108:111], v[188:191], v[144:159]
    ds_read_b128 v[116:119], v217
    ds_read_b64_tr_b16 v[184:185], v210 offset:2048
    ds_read_b64_tr_b16 v[186:187], v210 offset:2560
    ds_read_b64_tr_b16 v[188:189], v211 offset:2048
    ds_read_b64_tr_b16 v[190:191], v211 offset:2560
    s_waitcnt lgkmcnt(5)
    v_mfma_f32_32x32x16_bf16 v[128:143], v[176:179], v[112:115], v[128:143]
    v_mfma_f32_32x32x16_bf16 v[144:159], v[112:115], v[180:183], v[144:159]
    ds_read_b128 v[120:123], v218
    ds_read_b64_tr_b16 v[176:177], v210 offset:4096
    ds_read_b64_tr_b16 v[178:179], v210 offset:4608
    ds_read_b64_tr_b16 v[180:181], v211 offset:4096
    ds_read_b64_tr_b16 v[182:183], v211 offset:4608
    s_waitcnt lgkmcnt(5)
    v_mfma_f32_32x32x16_bf16 v[128:143], v[184:187], v[116:119], v[128:143]
    v_mfma_f32_32x32x16_bf16 v[144:159], v[116:119], v[188:191], v[144:159]
    ds_read_b128 v[124:127], v219
    ds_read_b64_tr_b16 v[184:185], v210 offset:6144
    ds_read_b64_tr_b16 v[186:187], v210 offset:6656
    ds_read_b64_tr_b16 v[188:189], v211 offset:6144
    ds_read_b64_tr_b16 v[190:191], v211 offset:6656
    s_waitcnt lgkmcnt(5)
    v_mfma_f32_32x32x16_bf16 v[128:143], v[176:179], v[120:123], v[128:143]
    v_mfma_f32_32x32x16_bf16 v[144:159], v[120:123], v[180:183], v[144:159]
    s_waitcnt lgkmcnt(0)
    v_mfma_f32_32x32x16_bf16 v[128:143], v[184:187], v[124:127], v[128:143]
    v_mfma_f32_32x32x16_bf16 v[144:159], v[124:127], v[188:191], v[144:159]
    v_mov_b32 v4, 160920
    s_mov_b64 exec, 1
    ds_add_u32 v4, v248
    s_mov_b64 exec, -1
    v_readfirstlane_b32 s52, v240
    v_readfirstlane_b32 s53, v241
    s_nop 3
    s_or_b32 s56, s52, s53
    s_cbranch_scc1 L_nonce_doneB
    s_mov_b32 s97, 0x40000
L_nonceB:
    buffer_load_dwordx2 v[240:241], v242, s[44:47], 0 offen sc1
    s_waitcnt vmcnt(0)
    v_readfirstlane_b32 s52, v240
    v_readfirstlane_b32 s53, v241
    s_nop 3
    s_or_b32 s56, s52, s53
    s_cbranch_scc1 L_nonce_doneB
    s_sub_u32 s97, s97, 1
    s_cbranch_scc1 L_nonce_doneB
    s_sleep 2
    s_branch L_nonceB
L_nonce_doneB:
    s_mov_b32 s64, 0
    s_mov_b32 s65, -1
    s_mov_b32 s66, 1114129
    s_mov_b32 s67, 1114129
    v_mov_b32 v14, 0x3f803f80
    s_lshl_b32 s56, s48, 18
    s_lshl_b32 s57, s49, 2
    s_add_u32 s57, s57, s3
    s_lshl_b32 s57, s57, 12
    s_add_u32 s56, s56, s57
    s_nop 4
    v_cvt_pk_bf16_f32 v160, v128, v129
    v_cvt_pk_bf16_f32 v161, v130, v131
    v_cvt_pk_bf16_f32 v162, v132, v133
    v_cvt_pk_bf16_f32 v163, v134, v135
    v_cvt_pk_bf16_f32 v164, v136, v137
    v_cvt_pk_bf16_f32 v165, v138, v139
    v_cvt_pk_bf16_f32 v166, v140, v141
    v_cvt_pk_bf16_f32 v167, v142, v143
    v_cndmask_b32 v166, v166, v14, s[64:65]
    v_cndmask_b32 v167, v167, v14, s[64:65]
    v_cvt_pk_bf16_f32 v168, v144, v145
    v_cvt_pk_bf16_f32 v169, v146, v147
    v_cvt_pk_bf16_f32 v170, v148, v149
    v_cvt_pk_bf16_f32 v171, v150, v151
    v_cvt_pk_bf16_f32 v172, v152, v153
    v_cvt_pk_bf16_f32 v173, v154, v155
    v_cvt_pk_bf16_f32 v174, v156, v157
    v_cvt_pk_bf16_f32 v175, v158, v159
    buffer_store_dwordx4 v[160:163], v2, s[40:43], s56 offen offset:0 sc1
    buffer_store_dwordx4 v[164:167], v2, s[40:43], s56 offen offset:1024 sc1
    v_cndmask_b32 v168, v168, v14, s[66:67]
    v_cndmask_b32 v169, v169, v14, s[66:67]
    v_cndmask_b32 v170, v170, v14, s[66:67]
    v_cndmask_b32 v171, v171, v14, s[66:67]
    v_cndmask_b32 v172, v172, v14, s[66:67]
    v_cndmask_b32 v173, v173, v14, s[66:67]
    v_cndmask_b32 v174, v174, v14, s[66:67]
    v_cndmask_b32 v175, v175, v14, s[66:67]
    buffer_store_dwordx4 v[168:171], v2, s[40:43], s56 offen offset:2048 sc1
    buffer_store_dwordx4 v[172:175], v2, s[40:43], s56 offen offset:3072 sc1
    s_waitcnt vmcnt(4)
    s_add_u32 s55, s55, 4
    s_mov_b64 exec, 1
    ds_add_u32 v247, v248
    s_mov_b64 exec, -1
    s_mov_b32 s97, 0x100000
L_sw8:
    ds_read_b32 v249, v247
    s_waitcnt lgkmcnt(0)
    v_readfirstlane_b32 s95, v249
    s_cmp_ge_u32 s95, s55
    s_cbranch_scc1 L_swd8
    s_sub_u32 s97, s97, 1
    s_cbranch_scc0 L_sw8
L_swd8:
    ds_read_b64_tr_b16 v[176:177], v220 offset:0
    ds_read_b64_tr_b16 v[178:179], v220 offset:256
    ds_read_b64_tr_b16 v[180:181], v220 offset:1024
    ds_read_b64_tr_b16 v[182:183], v220 offset:1280
    ds_read_b64_tr_b16 v[184:185], v220 offset:2048
    ds_read_b64_tr_b16 v[186:187], v220 offset:2304
    ds_read_b64_tr_b16 v[188:189], v220 offset:3072
    ds_read_b64_tr_b16 v[190:191], v220 offset:3328
    s_waitcnt lgkmcnt(6)
    v_mfma_f32_32x32x16_bf16 v[224:239], v[176:179], v[16:19], 0
    ds_read_b64_tr_b16 v[176:177], v220 offset:4096
    ds_read_b64_tr_b16 v[178:179], v220 offset:4352
    s_waitcnt lgkmcnt(6)
    v_mfma_f32_32x32x16_bf16 v[224:239], v[180:183], v[20:23], v[224:239]
    ds_read_b64_tr_b16 v[180:181], v220 offset:5120
    ds_read_b64_tr_b16 v[182:183], v220 offset:5376
    s_waitcnt lgkmcnt(6)
    v_mfma_f32_32x32x16_bf16 v[224:239], v[184:187], v[24:27], v[224:239]
    ds_read_b64_tr_b16 v[184:185], v220 offset:6144
    ds_read_b64_tr_b16 v[186:187], v220 offset:6400
    s_waitcnt lgkmcnt(6)
    v_mfma_f32_32x32x16_bf16 v[224:239], v[188:191], v[28:31], v[224:239]
    ds_read_b64_tr_b16 v[188:189], v220 offset:7168
    ds_read_b64_tr_b16 v[190:191], v220 offset:7424
    s_waitcnt lgkmcnt(6)
    v_mfma_f32_32x32x16_bf16 v[224:239], v[176:179], v[32:35], v[224:239]
    ds_read_b64_tr_b16 v[176:177], v220 offset:8192
    ds_read_b64_tr_b16 v[178:179], v220 offset:8448
    s_waitcnt lgkmcnt(6)
    v_mfma_f32_32x32x16_bf16 v[224:239], v[180:183], v[36:39], v[224:239]
    ds_read_b64_tr_b16 v[180:181], v220 offset:9216
    ds_read_b64_tr_b16 v[182:183], v220 offset:9472
    s_waitcnt lgkmcnt(6)
    v_mfma_f32_32x32x16_bf16 v[224:239], v[184:187], v[40:43], v[224:239]
    ds_read_b64_tr_b16 v[184:185], v220 offset:10240
    ds_read_b64_tr_b16 v[186:187], v220 offset:10496
    s_waitcnt lgkmcnt(6)
    v_mfma_f32_32x32x16_bf16 v[224:239], v[188:191], v[44:47], v[224:239]
    ds_read_b64_tr_b16 v[188:189], v220 offset:11264
    ds_read_b64_tr_b16 v[190:191], v220 offset:11520
    s_waitcnt lgkmcnt(6)
    v_mfma_f32_32x32x16_bf16 v[224:239], v[176:179], v[48:51], v[224:239]
    ds_read_b64_tr_b16 v[176:177], v220 offset:12288
    ds_read_b64_tr_b16 v[178:179], v220 offset:12544
    s_waitcnt lgkmcnt(6)
    v_mfma_f32_32x32x16_bf16 v[224:239], v[180:183], v[52:55], v[224:239]
    ds_read_b64_tr_b16 v[180:181], v220 offset:13312
    ds_read_b64_tr_b16 v[182:183], v220 offset:13568
    s_waitcnt lgkmcnt(6)
    v_mfma_f32_32x32x16_bf16 v[224:239], v[184:187], v[56:59], v[224:239]
    s_waitcnt vmcnt(0)
    s_lshl_b32 s56, s48, 4
    s_add_u32 s56, s56, s49
    s_lshl_b32 s56, s56, 2
    s_add_u32 s56, s56, s3
    s_lshl_b32 s56, s56, 6
    s_add_u32 s56, s56, 10551296
    v_mov_b32 v4, s52
    v_mov_b32 v5, s53
    v_mov_b32 v6, 0
    s_mov_b64 exec, 1
    buffer_store_dwordx2 v[4:5], v6, s[40:43], s56 offen sc1
    s_mov_b64 exec, -1
    ds_read_b64_tr_b16 v[184:185], v220 offset:14336
    ds_read_b64_tr_b16 v[186:187], v220 offset:14592
    s_waitcnt lgkmcnt(6)
    v_mfma_f32_32x32x16_bf16 v[224:239], v[188:191], v[60:63], v[224:239]
    ds_read_b64_tr_b16 v[188:189], v220 offset:15360
    ds_read_b64_tr_b16 v[190:191], v220 offset:15616
    s_waitcnt lgkmcnt(6)
    v_mfma_f32_32x32x16_bf16 v[224:239], v[176:179], v[64:67], v[224:239]
    ds_read_b64_tr_b16 v[176:177], v220 offset:16384
    ds_read_b64_tr_b16 v[178:179], v220 offset:16640
    s_waitcnt lgkmcnt(6)
    v_mfma_f32_32x32x16_bf16 v[224:239], v[180:183], v[68:71], v[224:239]
    ds_read_b64_tr_b16 v[180:181], v220 offset:17408
    ds_read_b64_tr_b16 v[182:183], v220 offset:17664
    s_waitcnt lgkmcnt(6)
    v_mfma_f32_32x32x16_bf16 v[224:239], v[184:187], v[72:75], v[224:239]
    ds_read_b64_tr_b16 v[184:185], v220 offset:18432
    ds_read_b64_tr_b16 v[186:187], v220 offset:18688
    s_waitcnt lgkmcnt(6)
    v_mfma_f32_32x32x16_bf16 v[224:239], v[188:191], v[76:79], v[224:239]
    ds_read_b64_tr_b16 v[188:189], v220 offset:19456
    ds_read_b64_tr_b16 v[190:191], v220 offset:19712
    s_waitcnt lgkmcnt(6)
    v_mfma_f32_32x32x16_bf16 v[224:239], v[176:179], v[80:83], v[224:239]
    ds_read_b64_tr_b16 v[176:177], v220 offset:20480
    ds_read_b64_tr_b16 v[178:179], v220 offset:20736
    s_waitcnt lgkmcnt(6)
    v_mfma_f32_32x32x16_bf16 v[224:239], v[180:183], v[84:87], v[224:239]
    ds_read_b64_tr_b16 v[180:181], v220 offset:21504
    ds_read_b64_tr_b16 v[182:183], v220 offset:21760
    s_waitcnt lgkmcnt(6)
    v_mfma_f32_32x32x16_bf16 v[224:239], v[184:187], v[88:91], v[224:239]
    ds_read_b64_tr_b16 v[184:185], v220 offset:22528
    ds_read_b64_tr_b16 v[186:187], v220 offset:22784
    s_waitcnt lgkmcnt(6)
    v_mfma_f32_32x32x16_bf16 v[224:239], v[188:191], v[92:95], v[224:239]
    ds_read_b64_tr_b16 v[188:189], v220 offset:23552
    ds_read_b64_tr_b16 v[190:191], v220 offset:23808
    s_waitcnt lgkmcnt(6)
    v_mfma_f32_32x32x16_bf16 v[224:239], v[176:179], v[96:99], v[224:239]
    ds_read_b64_tr_b16 v[176:177], v220 offset:24576
    ds_read_b64_tr_b16 v[178:179], v220 offset:24832
    s_waitcnt lgkmcnt(6)
    v_mfma_f32_32x32x16_bf16 v[224:239], v[180:183], v[100:103], v[224:239]
    ds_read_b64_tr_b16 v[180:181], v220 offset:25600
    ds_read_b64_tr_b16 v[182:183], v220 offset:25856
    s_waitcnt lgkmcnt(6)
    v_mfma_f32_32x32x16_bf16 v[224:239], v[184:187], v[104:107], v[224:239]
    ds_read_b64_tr_b16 v[184:185], v220 offset:26624
    ds_read_b64_tr_b16 v[186:187], v220 offset:26880
    s_waitcnt lgkmcnt(6)
    v_mfma_f32_32x32x16_bf16 v[224:239], v[188:191], v[108:111], v[224:239]
    ds_read_b64_tr_b16 v[188:189], v220 offset:27648
    ds_read_b64_tr_b16 v[190:191], v220 offset:27904
    s_waitcnt lgkmcnt(6)
    v_mfma_f32_32x32x16_bf16 v[224:239], v[176:179], v[112:115], v[224:239]
    s_waitcnt lgkmcnt(4)
    v_mfma_f32_32x32x16_bf16 v[224:239], v[180:183], v[116:119], v[224:239]
    s_waitcnt lgkmcnt(2)
    v_mfma_f32_32x32x16_bf16 v[224:239], v[184:187], v[120:123], v[224:239]
    s_waitcnt lgkmcnt(0)
    v_mfma_f32_32x32x16_bf16 v[224:239], v[188:191], v[124:127], v[224:239]
    s_mov_b32 s58, 1049335798
    s_lshl_b32 s57, s3, 11
    s_add_u32 s57, s57, 65536
    v_add_u32 v3, s57, v2
    s_nop 7
    s_nop 1
    v_mul_f32 v224, s58, v224
    v_mul_f32 v225, s58, v225
    v_mul_f32 v226, s58, v226
    v_mul_f32 v227, s58, v227
    v_mul_f32 v228, s58, v228
    v_mul_f32 v229, s58, v229
    v_mul_f32 v230, s58, v230
    v_mul_f32 v231, s58, v231
    v_mul_f32 v232, s58, v232
    v_mul_f32 v233, s58, v233
    v_mul_f32 v234, s58, v234
    v_mul_f32 v235, s58, v235
    v_mul_f32 v236, s58, v236
    v_mul_f32 v237, s58, v237
    v_mul_f32 v238, s58, v238
    v_mul_f32 v239, s58, v239
    v_cvt_pk_bf16_f32 v16, v224, v225
    v_cvt_pk_bf16_f32 v17, v226, v227
    v_cvt_pk_bf16_f32 v18, v228, v229
    v_cvt_pk_bf16_f32 v19, v230, v231
    v_cvt_pk_bf16_f32 v20, v232, v233
    v_cvt_pk_bf16_f32 v21, v234, v235
    v_cvt_pk_bf16_f32 v22, v236, v237
    v_cvt_pk_bf16_f32 v23, v238, v239
    v_cndmask_b32 v22, v22, 0, s[64:65]
    v_cndmask_b32 v23, v23, 0, s[64:65]
    ds_write_b128 v3, v[16:19]
    ds_write_b128 v3, v[20:23] offset:1024
    s_add_u32 s55, s55, 4
    s_mov_b64 exec, 1
    ds_add_u32 v247, v248
    s_mov_b64 exec, -1
    s_mov_b32 s97, 0x100000
L_sw9:
    ds_read_b32 v249, v247
    s_waitcnt lgkmcnt(0)
    v_readfirstlane_b32 s95, v249
    s_cmp_ge_u32 s95, s55
    s_cbranch_scc1 L_swd9
    s_sub_u32 s97, s97, 1
    s_cbranch_scc0 L_sw9
L_swd9:
    s_setprio 0
    s_lshl_b32 s56, s48, 6
    s_add_u32 s56, s56, s3
    v_and_b32 v7, 15, v1
    v_lshlrev_b32 v7, 2, v7
    v_add_u32 v7, s56, v7
    v_add_u32 v3, 65536, v2
    ds_read_b128 v[128:131], v3 offset:0
    ds_read_b128 v[132:135], v3 offset:1024
    ds_read_b128 v[136:139], v3 offset:2048
    ds_read_b128 v[140:143], v3 offset:3072
    ds_read_b128 v[144:147], v3 offset:4096
    ds_read_b128 v[148:151], v3 offset:5120
    ds_read_b128 v[152:155], v3 offset:6144
    ds_read_b128 v[156:159], v3 offset:7168
    s_lshl_b32 s70, s48, 18
    s_lshl_b32 s56, s3, 12
    s_add_u32 s70, s70, s56
    v_add_u32 v235, s70, v2
    v_lshlrev_b32 v7, 6, v7
    v_add_u32 v7, 10551296, v7
    s_mov_b32 s97, 0x40000
L_poll_b1:
    buffer_load_dwordx2 v[4:5], v7, s[40:43], 0 offen sc1
    s_waitcnt vmcnt(0)
    v_cmp_ne_u64 vcc, s[52:53], v[4:5]
    s_cbranch_vccz L_poll_done_b1
    s_sub_u32 s97, s97, 1
    s_cbranch_scc1 L_poll_done_b1
    s_sleep 3
    s_branch L_poll_b1
L_poll_done_b1:
    s_mov_b32 s96, 0
L_attn_start:
    s_lshl_b32 s71, s49, 14
    s_add_u32 s71, s71, 16384
    s_and_b32 s71, s71, 0x3ffff
    buffer_load_dwordx4 v[176:179], v235, s[40:43], s71 offen offset:0 sc1
    buffer_load_dwordx4 v[180:183], v235, s[40:43], s71 offen offset:1024 sc1
    buffer_load_dwordx4 v[184:187], v235, s[40:43], s71 offen offset:2048 sc1
    buffer_load_dwordx4 v[188:191], v235, s[40:43], s71 offen offset:3072 sc1
    s_add_u32 s71, s71, 16384
    s_and_b32 s71, s71, 0x3ffff
    buffer_load_dwordx4 v[192:195], v235, s[40:43], s71 offen offset:0 sc1
    buffer_load_dwordx4 v[196:199], v235, s[40:43], s71 offen offset:1024 sc1
    buffer_load_dwordx4 v[200:203], v235, s[40:43], s71 offen offset:2048 sc1
    buffer_load_dwordx4 v[204:207], v235, s[40:43], s71 offen offset:3072 sc1
    s_add_u32 s71, s71, 16384
    s_and_b32 s71, s71, 0x3ffff
    buffer_load_dwordx4 v[208:211], v235, s[40:43], s71 offen offset:0 sc1
    buffer_load_dwordx4 v[212:215], v235, s[40:43], s71 offen offset:1024 sc1
    buffer_load_dwordx4 v[216:219], v235, s[40:43], s71 offen offset:2048 sc1
    buffer_load_dwordx4 v[220:223], v235, s[40:43], s71 offen offset:3072 sc1
    s_waitcnt lgkmcnt(0)
    v_mfma_f32_32x32x16_bf16 v[16:31], v[160:163], v[128:131], 0
    v_mfma_f32_32x32x16_bf16 v[16:31], v[164:167], v[132:135], v[16:31]
    s_nop 7
    s_nop 3
    v_mfma_f32_32x32x16_bf16 v[32:47], v[160:163], v[136:139], 0
    v_exp_f32 v16, v16
    v_exp_f32 v17, v17
    v_exp_f32 v18, v18
    v_exp_f32 v19, v19
    v_cvt_pk_bf16_f32 v48, v16, v17
    v_cvt_pk_bf16_f32 v49, v18, v19
    v_mfma_f32_32x32x16_bf16 v[32:47], v[164:167], v[140:143], v[32:47]
    v_exp_f32 v20, v20
    v_exp_f32 v21, v21
    v_exp_f32 v22, v22
    v_exp_f32 v23, v23
    v_cvt_pk_bf16_f32 v50, v20, v21
    v_cvt_pk_bf16_f32 v51, v22, v23
    v_exp_f32 v24, v24
    v_exp_f32 v25, v25
    v_exp_f32 v26, v26
    v_exp_f32 v27, v27
    v_cvt_pk_bf16_f32 v52, v24, v25
    v_cvt_pk_bf16_f32 v53, v26, v27
    v_exp_f32 v28, v28
    v_exp_f32 v29, v29
    v_exp_f32 v30, v30
    v_exp_f32 v31, v31
    v_cvt_pk_bf16_f32 v54, v28, v29
    v_cvt_pk_bf16_f32 v55, v30, v31
    v_mfma_f32_32x32x16_bf16 v[16:31], v[160:163], v[144:147], 0
    v_exp_f32 v32, v32
    v_exp_f32 v33, v33
    v_exp_f32 v34, v34
    v_exp_f32 v35, v35
    v_cvt_pk_bf16_f32 v56, v32, v33
    v_cvt_pk_bf16_f32 v57, v34, v35
    v_mfma_f32_32x32x16_bf16 v[16:31], v[164:167], v[148:151], v[16:31]
    v_exp_f32 v36, v36
    v_exp_f32 v37, v37
    v_exp_f32 v38, v38
    v_exp_f32 v39, v39
    v_cvt_pk_bf16_f32 v58, v36, v37
    v_cvt_pk_bf16_f32 v59, v38, v39
    v_mfma_f32_32x32x16_bf16 v[64:79], v[168:171], v[48:51], 0
    v_exp_f32 v40, v40
    v_exp_f32 v41, v41
    v_exp_f32 v42, v42
    v_exp_f32 v43, v43
    v_cvt_pk_bf16_f32 v60, v40, v41
    v_cvt_pk_bf16_f32 v61, v42, v43
    v_mfma_f32_32x32x16_bf16 v[64:79], v[172:175], v[52:55], v[64:79]
    v_exp_f32 v44, v44
    v_exp_f32 v45, v45
    v_exp_f32 v46, v46
    v_exp_f32 v47, v47
    v_cvt_pk_bf16_f32 v62, v44, v45
    v_cvt_pk_bf16_f32 v63, v46, v47
    v_mfma_f32_32x32x16_bf16 v[32:47], v[160:163], v[152:155], 0
    v_exp_f32 v16, v16
    v_exp_f32 v17, v17
    v_exp_f32 v18, v18
    v_exp_f32 v19, v19
    v_cvt_pk_bf16_f32 v48, v16, v17
    v_cvt_pk_bf16_f32 v49, v18, v19
    v_mfma_f32_32x32x16_bf16 v[32:47], v[164:167], v[156:159], v[32:47]
    v_exp_f32 v20, v20
    v_exp_f32 v21, v21
    v_exp_f32 v22, v22
    v_exp_f32 v23, v23
    v_cvt_pk_bf16_f32 v50, v20, v21
    v_cvt_pk_bf16_f32 v51, v22, v23
    v_mfma_f32_32x32x16_bf16 v[80:95], v[168:171], v[56:59], 0
    v_exp_f32 v24, v24
    v_exp_f32 v25, v25
    v_exp_f32 v26, v26
    v_exp_f32 v27, v27
    v_cvt_pk_bf16_f32 v52, v24, v25
    v_cvt_pk_bf16_f32 v53, v26, v27
    v_mfma_f32_32x32x16_bf16 v[80:95], v[172:175], v[60:63], v[80:95]
    v_exp_f32 v28, v28
    v_exp_f32 v29, v29
    v_exp_f32 v30, v30
    v_exp_f32 v31, v31
    v_cvt_pk_bf16_f32 v54, v28, v29
    v_cvt_pk_bf16_f32 v55, v30, v31
    s_waitcnt vmcnt(8)
    v_mfma_f32_32x32x16_bf16 v[16:31], v[176:179], v[128:131], 0
    v_exp_f32 v32, v32
    v_exp_f32 v33, v33
    v_exp_f32 v34, v34
    v_exp_f32 v35, v35
    v_cvt_pk_bf16_f32 v56, v32, v33
    v_cvt_pk_bf16_f32 v57, v34, v35
    v_mfma_f32_32x32x16_bf16 v[16:31], v[180:183], v[132:135], v[16:31]
    v_exp_f32 v36, v36
    v_exp_f32 v37, v37
    v_exp_f32 v38, v38
    v_exp_f32 v39, v39
    v_cvt_pk_bf16_f32 v58, v36, v37
    v_cvt_pk_bf16_f32 v59, v38, v39
    v_mfma_f32_32x32x16_bf16 v[96:111], v[168:171], v[48:51], 0
    v_exp_f32 v40, v40
    v_exp_f32 v41, v41
    v_exp_f32 v42, v42
    v_exp_f32 v43, v43
    v_cvt_pk_bf16_f32 v60, v40, v41
    v_cvt_pk_bf16_f32 v61, v42, v43
    v_mfma_f32_32x32x16_bf16 v[96:111], v[172:175], v[52:55], v[96:111]
    v_exp_f32 v44, v44
    v_exp_f32 v45, v45
    v_exp_f32 v46, v46
    v_exp_f32 v47, v47
    v_cvt_pk_bf16_f32 v62, v44, v45
    v_cvt_pk_bf16_f32 v63, v46, v47
    v_mfma_f32_32x32x16_bf16 v[32:47], v[176:179], v[136:139], 0
    v_exp_f32 v16, v16
    v_exp_f32 v17, v17
    v_exp_f32 v18, v18
    v_exp_f32 v19, v19
    v_cvt_pk_bf16_f32 v48, v16, v17
    v_cvt_pk_bf16_f32 v49, v18, v19
    v_mfma_f32_32x32x16_bf16 v[32:47], v[180:183], v[140:143], v[32:47]
    v_exp_f32 v20, v20
    v_exp_f32 v21, v21
    v_exp_f32 v22, v22
    v_exp_f32 v23, v23
    v_cvt_pk_bf16_f32 v50, v20, v21
    v_cvt_pk_bf16_f32 v51, v22, v23
    v_mfma_f32_32x32x16_bf16 v[112:127], v[168:171], v[56:59], 0
    v_exp_f32 v24, v24
    v_exp_f32 v25, v25
    v_exp_f32 v26, v26
    v_exp_f32 v27, v27
    v_cvt_pk_bf16_f32 v52, v24, v25
    v_cvt_pk_bf16_f32 v53, v26, v27
    v_mfma_f32_32x32x16_bf16 v[112:127], v[172:175], v[60:63], v[112:127]
    v_exp_f32 v28, v28
    v_exp_f32 v29, v29
    v_exp_f32 v30, v30
    v_exp_f32 v31, v31
    v_cvt_pk_bf16_f32 v54, v28, v29
    v_cvt_pk_bf16_f32 v55, v30, v31
    s_mov_b32 s97, 0
    .p2align 3
L_attn_loop:
    v_mfma_f32_32x32x16_bf16 v[16:31], v[176:179], v[144:147], 0
    v_exp_f32 v32, v32
    v_exp_f32 v33, v33
    v_exp_f32 v34, v34
    v_exp_f32 v35, v35
    v_cvt_pk_bf16_f32 v56, v32, v33
    v_cvt_pk_bf16_f32 v57, v34, v35
    v_mfma_f32_32x32x16_bf16 v[16:31], v[180:183], v[148:151], v[16:31]
    v_exp_f32 v36, v36
    v_exp_f32 v37, v37
    v_exp_f32 v38, v38
    v_exp_f32 v39, v39
    v_cvt_pk_bf16_f32 v58, v36, v37
    v_cvt_pk_bf16_f32 v59, v38, v39
    v_mfma_f32_32x32x16_bf16 v[64:79], v[184:187], v[48:51], v[64:79]
    s_add_u32 s71, s71, 16384
    s_and_b32 s71, s71, 0x3ffff
    buffer_load_dwordx4 v[160:163], v235, s[40:43], s71 offen offset:0 sc1
    buffer_load_dwordx4 v[164:167], v235, s[40:43], s71 offen offset:1024 sc1
    buffer_load_dwordx4 v[168:171], v235, s[40:43], s71 offen offset:2048 sc1
    buffer_load_dwordx4 v[172:175], v235, s[40:43], s71 offen offset:3072 sc1
    v_exp_f32 v40, v40
    v_exp_f32 v41, v41
    v_exp_f32 v42, v42
    v_exp_f32 v43, v43
    v_cvt_pk_bf16_f32 v60, v40, v41
    v_cvt_pk_bf16_f32 v61, v42, v43
    v_mfma_f32_32x32x16_bf16 v[64:79], v[188:191], v[52:55], v[64:79]
    v_exp_f32 v44, v44
    v_exp_f32 v45, v45
    v_exp_f32 v46, v46
    v_exp_f32 v47, v47
    v_cvt_pk_bf16_f32 v62, v44, v45
    v_cvt_pk_bf16_f32 v63, v46, v47
    v_mfma_f32_32x32x16_bf16 v[32:47], v[176:179], v[152:155], 0
    v_exp_f32 v16, v16
    v_exp_f32 v17, v17
    v_exp_f32 v18, v18
    v_exp_f32 v19, v19
    v_cvt_pk_bf16_f32 v48, v16, v17
    v_cvt_pk_bf16_f32 v49, v18, v19
    v_mfma_f32_32x32x16_bf16 v[32:47], v[180:183], v[156:159], v[32:47]
    v_exp_f32 v20, v20
    v_exp_f32 v21, v21
    v_exp_f32 v22, v22
    v_exp_f32 v23, v23
    v_cvt_pk_bf16_f32 v50, v20, v21
    v_cvt_pk_bf16_f32 v51, v22, v23
    v_mfma_f32_32x32x16_bf16 v[80:95], v[184:187], v[56:59], v[80:95]
    v_exp_f32 v24, v24
    v_exp_f32 v25, v25
    v_exp_f32 v26, v26
    v_exp_f32 v27, v27
    v_cvt_pk_bf16_f32 v52, v24, v25
    v_cvt_pk_bf16_f32 v53, v26, v27
    v_mfma_f32_32x32x16_bf16 v[80:95], v[188:191], v[60:63], v[80:95]
    v_exp_f32 v28, v28
    v_exp_f32 v29, v29
    v_exp_f32 v30, v30
    v_exp_f32 v31, v31
    v_cvt_pk_bf16_f32 v54, v28, v29
    v_cvt_pk_bf16_f32 v55, v30, v31
    s_waitcnt vmcnt(8)
    v_mfma_f32_32x32x16_bf16 v[16:31], v[192:195], v[128:131], 0
    v_exp_f32 v32, v32
    v_exp_f32 v33, v33
    v_exp_f32 v34, v34
    v_exp_f32 v35, v35
    v_cvt_pk_bf16_f32 v56, v32, v33
    v_cvt_pk_bf16_f32 v57, v34, v35
    v_mfma_f32_32x32x16_bf16 v[16:31], v[196:199], v[132:135], v[16:31]
    v_exp_f32 v36, v36
    v_exp_f32 v37, v37
    v_exp_f32 v38, v38
    v_exp_f32 v39, v39
    v_cvt_pk_bf16_f32 v58, v36, v37
    v_cvt_pk_bf16_f32 v59, v38, v39
    v_mfma_f32_32x32x16_bf16 v[96:111], v[184:187], v[48:51], v[96:111]
    v_exp_f32 v40, v40
    v_exp_f32 v41, v41
    v_exp_f32 v42, v42
    v_exp_f32 v43, v43
    v_cvt_pk_bf16_f32 v60, v40, v41
    v_cvt_pk_bf16_f32 v61, v42, v43
    v_mfma_f32_32x32x16_bf16 v[96:111], v[188:191], v[52:55], v[96:111]
    v_exp_f32 v44, v44
    v_exp_f32 v45, v45
    v_exp_f32 v46, v46
    v_exp_f32 v47, v47
    v_cvt_pk_bf16_f32 v62, v44, v45
    v_cvt_pk_bf16_f32 v63, v46, v47
    v_mfma_f32_32x32x16_bf16 v[32:47], v[192:195], v[136:139], 0
    v_exp_f32 v16, v16
    v_exp_f32 v17, v17
    v_exp_f32 v18, v18
    v_exp_f32 v19, v19
    v_cvt_pk_bf16_f32 v48, v16, v17
    v_cvt_pk_bf16_f32 v49, v18, v19
    v_mfma_f32_32x32x16_bf16 v[32:47], v[196:199], v[140:143], v[32:47]
    v_exp_f32 v20, v20
    v_exp_f32 v21, v21
    v_exp_f32 v22, v22
    v_exp_f32 v23, v23
    v_cvt_pk_bf16_f32 v50, v20, v21
    v_cvt_pk_bf16_f32 v51, v22, v23
    v_mfma_f32_32x32x16_bf16 v[112:127], v[184:187], v[56:59], v[112:127]
    v_exp_f32 v24, v24
    v_exp_f32 v25, v25
    v_exp_f32 v26, v26
    v_exp_f32 v27, v27
    v_cvt_pk_bf16_f32 v52, v24, v25
    v_cvt_pk_bf16_f32 v53, v26, v27
    v_mfma_f32_32x32x16_bf16 v[112:127], v[188:191], v[60:63], v[112:127]
    v_exp_f32 v28, v28
    v_exp_f32 v29, v29
    v_exp_f32 v30, v30
    v_exp_f32 v31, v31
    v_cvt_pk_bf16_f32 v54, v28, v29
    v_cvt_pk_bf16_f32 v55, v30, v31
    v_mfma_f32_32x32x16_bf16 v[16:31], v[192:195], v[144:147], 0
    v_exp_f32 v32, v32
    v_exp_f32 v33, v33
    v_exp_f32 v34, v34
    v_exp_f32 v35, v35
    v_cvt_pk_bf16_f32 v56, v32, v33
    v_cvt_pk_bf16_f32 v57, v34, v35
    v_mfma_f32_32x32x16_bf16 v[16:31], v[196:199], v[148:151], v[16:31]
    v_exp_f32 v36, v36
    v_exp_f32 v37, v37
    v_exp_f32 v38, v38
    v_exp_f32 v39, v39
    v_cvt_pk_bf16_f32 v58, v36, v37
    v_cvt_pk_bf16_f32 v59, v38, v39
    v_mfma_f32_32x32x16_bf16 v[64:79], v[200:203], v[48:51], v[64:79]
    s_add_u32 s71, s71, 16384
    s_and_b32 s71, s71, 0x3ffff
    buffer_load_dwordx4 v[176:179], v235, s[40:43], s71 offen offset:0 sc1
    buffer_load_dwordx4 v[180:183], v235, s[40:43], s71 offen offset:1024 sc1
    buffer_load_dwordx4 v[184:187], v235, s[40:43], s71 offen offset:2048 sc1
    buffer_load_dwordx4 v[188:191], v235, s[40:43], s71 offen offset:3072 sc1
    v_exp_f32 v40, v40
    v_exp_f32 v41, v41
    v_exp_f32 v42, v42
    v_exp_f32 v43, v43
    v_cvt_pk_bf16_f32 v60, v40, v41
    v_cvt_pk_bf16_f32 v61, v42, v43
    v_mfma_f32_32x32x16_bf16 v[64:79], v[204:207], v[52:55], v[64:79]
    v_exp_f32 v44, v44
    v_exp_f32 v45, v45
    v_exp_f32 v46, v46
    v_exp_f32 v47, v47
    v_cvt_pk_bf16_f32 v62, v44, v45
    v_cvt_pk_bf16_f32 v63, v46, v47
    v_mfma_f32_32x32x16_bf16 v[32:47], v[192:195], v[152:155], 0
    v_exp_f32 v16, v16
    v_exp_f32 v17, v17
    v_exp_f32 v18, v18
    v_exp_f32 v19, v19
    v_cvt_pk_bf16_f32 v48, v16, v17
    v_cvt_pk_bf16_f32 v49, v18, v19
    v_mfma_f32_32x32x16_bf16 v[32:47], v[196:199], v[156:159], v[32:47]
    v_exp_f32 v20, v20
    v_exp_f32 v21, v21
    v_exp_f32 v22, v22
    v_exp_f32 v23, v23
    v_cvt_pk_bf16_f32 v50, v20, v21
    v_cvt_pk_bf16_f32 v51, v22, v23
    v_mfma_f32_32x32x16_bf16 v[80:95], v[200:203], v[56:59], v[80:95]
    v_exp_f32 v24, v24
    v_exp_f32 v25, v25
    v_exp_f32 v26, v26
    v_exp_f32 v27, v27
    v_cvt_pk_bf16_f32 v52, v24, v25
    v_cvt_pk_bf16_f32 v53, v26, v27
    v_mfma_f32_32x32x16_bf16 v[80:95], v[204:207], v[60:63], v[80:95]
    v_exp_f32 v28, v28
    v_exp_f32 v29, v29
    v_exp_f32 v30, v30
    v_exp_f32 v31, v31
    v_cvt_pk_bf16_f32 v54, v28, v29
    v_cvt_pk_bf16_f32 v55, v30, v31
    s_waitcnt vmcnt(8)
    v_mfma_f32_32x32x16_bf16 v[16:31], v[208:211], v[128:131], 0
    v_exp_f32 v32, v32
    v_exp_f32 v33, v33
    v_exp_f32 v34, v34
    v_exp_f32 v35, v35
    v_cvt_pk_bf16_f32 v56, v32, v33
    v_cvt_pk_bf16_f32 v57, v34, v35
    v_mfma_f32_32x32x16_bf16 v[16:31], v[212:215], v[132:135], v[16:31]
    v_exp_f32 v36, v36
    v_exp_f32 v37, v37
    v_exp_f32 v38, v38
    v_exp_f32 v39, v39
    v_cvt_pk_bf16_f32 v58, v36, v37
    v_cvt_pk_bf16_f32 v59, v38, v39
    v_mfma_f32_32x32x16_bf16 v[96:111], v[200:203], v[48:51], v[96:111]
    v_exp_f32 v40, v40
    v_exp_f32 v41, v41
    v_exp_f32 v42, v42
    v_exp_f32 v43, v43
    v_cvt_pk_bf16_f32 v60, v40, v41
    v_cvt_pk_bf16_f32 v61, v42, v43
    v_mfma_f32_32x32x16_bf16 v[96:111], v[204:207], v[52:55], v[96:111]
    v_exp_f32 v44, v44
    v_exp_f32 v45, v45
    v_exp_f32 v46, v46
    v_exp_f32 v47, v47
    v_cvt_pk_bf16_f32 v62, v44, v45
    v_cvt_pk_bf16_f32 v63, v46, v47
    v_mfma_f32_32x32x16_bf16 v[32:47], v[208:211], v[136:139], 0
    v_exp_f32 v16, v16
    v_exp_f32 v17, v17
    v_exp_f32 v18, v18
    v_exp_f32 v19, v19
    v_cvt_pk_bf16_f32 v48, v16, v17
    v_cvt_pk_bf16_f32 v49, v18, v19
    v_mfma_f32_32x32x16_bf16 v[32:47], v[212:215], v[140:143], v[32:47]
    v_exp_f32 v20, v20
    v_exp_f32 v21, v21
    v_exp_f32 v22, v22
    v_exp_f32 v23, v23
    v_cvt_pk_bf16_f32 v50, v20, v21
    v_cvt_pk_bf16_f32 v51, v22, v23
    v_mfma_f32_32x32x16_bf16 v[112:127], v[200:203], v[56:59], v[112:127]
    v_exp_f32 v24, v24
    v_exp_f32 v25, v25
    v_exp_f32 v26, v26
    v_exp_f32 v27, v27
    v_cvt_pk_bf16_f32 v52, v24, v25
    v_cvt_pk_bf16_f32 v53, v26, v27
    v_mfma_f32_32x32x16_bf16 v[112:127], v[204:207], v[60:63], v[112:127]
    v_exp_f32 v28, v28
    v_exp_f32 v29, v29
    v_exp_f32 v30, v30
    v_exp_f32 v31, v31
    v_cvt_pk_bf16_f32 v54, v28, v29
    v_cvt_pk_bf16_f32 v55, v30, v31
    s_cmp_eq_u32 s97, 3
    s_cbranch_scc1 L_attn_tail
    v_mfma_f32_32x32x16_bf16 v[16:31], v[208:211], v[144:147], 0
    v_exp_f32 v32, v32
    v_exp_f32 v33, v33
    v_exp_f32 v34, v34
    v_exp_f32 v35, v35
    v_cvt_pk_bf16_f32 v56, v32, v33
    v_cvt_pk_bf16_f32 v57, v34, v35
    v_mfma_f32_32x32x16_bf16 v[16:31], v[212:215], v[148:151], v[16:31]
    v_exp_f32 v36, v36
    v_exp_f32 v37, v37
    v_exp_f32 v38, v38
    v_exp_f32 v39, v39
    v_cvt_pk_bf16_f32 v58, v36, v37
    v_cvt_pk_bf16_f32 v59, v38, v39
    v_mfma_f32_32x32x16_bf16 v[64:79], v[216:219], v[48:51], v[64:79]
    s_add_u32 s71, s71, 16384
    s_and_b32 s71, s71, 0x3ffff
    buffer_load_dwordx4 v[192:195], v235, s[40:43], s71 offen offset:0 sc1
    buffer_load_dwordx4 v[196:199], v235, s[40:43], s71 offen offset:1024 sc1
    buffer_load_dwordx4 v[200:203], v235, s[40:43], s71 offen offset:2048 sc1
    buffer_load_dwordx4 v[204:207], v235, s[40:43], s71 offen offset:3072 sc1
    v_exp_f32 v40, v40
    v_exp_f32 v41, v41
    v_exp_f32 v42, v42
    v_exp_f32 v43, v43
    v_cvt_pk_bf16_f32 v60, v40, v41
    v_cvt_pk_bf16_f32 v61, v42, v43
    v_mfma_f32_32x32x16_bf16 v[64:79], v[220:223], v[52:55], v[64:79]
    v_exp_f32 v44, v44
    v_exp_f32 v45, v45
    v_exp_f32 v46, v46
    v_exp_f32 v47, v47
    v_cvt_pk_bf16_f32 v62, v44, v45
    v_cvt_pk_bf16_f32 v63, v46, v47
    v_mfma_f32_32x32x16_bf16 v[32:47], v[208:211], v[152:155], 0
    v_exp_f32 v16, v16
    v_exp_f32 v17, v17
    v_exp_f32 v18, v18
    v_exp_f32 v19, v19
    v_cvt_pk_bf16_f32 v48, v16, v17
    v_cvt_pk_bf16_f32 v49, v18, v19
    v_mfma_f32_32x32x16_bf16 v[32:47], v[212:215], v[156:159], v[32:47]
    v_exp_f32 v20, v20
    v_exp_f32 v21, v21
    v_exp_f32 v22, v22
    v_exp_f32 v23, v23
    v_cvt_pk_bf16_f32 v50, v20, v21
    v_cvt_pk_bf16_f32 v51, v22, v23
    v_mfma_f32_32x32x16_bf16 v[80:95], v[216:219], v[56:59], v[80:95]
    v_exp_f32 v24, v24
    v_exp_f32 v25, v25
    v_exp_f32 v26, v26
    v_exp_f32 v27, v27
    v_cvt_pk_bf16_f32 v52, v24, v25
    v_cvt_pk_bf16_f32 v53, v26, v27
    v_mfma_f32_32x32x16_bf16 v[80:95], v[220:223], v[60:63], v[80:95]
    v_exp_f32 v28, v28
    v_exp_f32 v29, v29
    v_exp_f32 v30, v30
    v_exp_f32 v31, v31
    v_cvt_pk_bf16_f32 v54, v28, v29
    v_cvt_pk_bf16_f32 v55, v30, v31
    s_waitcnt vmcnt(8)
    v_mfma_f32_32x32x16_bf16 v[16:31], v[160:163], v[128:131], 0
    v_exp_f32 v32, v32
    v_exp_f32 v33, v33
    v_exp_f32 v34, v34
    v_exp_f32 v35, v35
    v_cvt_pk_bf16_f32 v56, v32, v33
    v_cvt_pk_bf16_f32 v57, v34, v35
    v_mfma_f32_32x32x16_bf16 v[16:31], v[164:167], v[132:135], v[16:31]
    v_exp_f32 v36, v36
    v_exp_f32 v37, v37
    v_exp_f32 v38, v38
    v_exp_f32 v39, v39
    v_cvt_pk_bf16_f32 v58, v36, v37
    v_cvt_pk_bf16_f32 v59, v38, v39
    v_mfma_f32_32x32x16_bf16 v[96:111], v[216:219], v[48:51], v[96:111]
    v_exp_f32 v40, v40
    v_exp_f32 v41, v41
    v_exp_f32 v42, v42
    v_exp_f32 v43, v43
    v_cvt_pk_bf16_f32 v60, v40, v41
    v_cvt_pk_bf16_f32 v61, v42, v43
    v_mfma_f32_32x32x16_bf16 v[96:111], v[220:223], v[52:55], v[96:111]
    v_exp_f32 v44, v44
    v_exp_f32 v45, v45
    v_exp_f32 v46, v46
    v_exp_f32 v47, v47
    v_cvt_pk_bf16_f32 v62, v44, v45
    v_cvt_pk_bf16_f32 v63, v46, v47
    v_mfma_f32_32x32x16_bf16 v[32:47], v[160:163], v[136:139], 0
    v_exp_f32 v16, v16
    v_exp_f32 v17, v17
    v_exp_f32 v18, v18
    v_exp_f32 v19, v19
    v_cvt_pk_bf16_f32 v48, v16, v17
    v_cvt_pk_bf16_f32 v49, v18, v19
    v_mfma_f32_32x32x16_bf16 v[32:47], v[164:167], v[140:143], v[32:47]
    v_exp_f32 v20, v20
    v_exp_f32 v21, v21
    v_exp_f32 v22, v22
    v_exp_f32 v23, v23
    v_cvt_pk_bf16_f32 v50, v20, v21
    v_cvt_pk_bf16_f32 v51, v22, v23
    v_mfma_f32_32x32x16_bf16 v[112:127], v[216:219], v[56:59], v[112:127]
    v_exp_f32 v24, v24
    v_exp_f32 v25, v25
    v_exp_f32 v26, v26
    v_exp_f32 v27, v27
    v_cvt_pk_bf16_f32 v52, v24, v25
    v_cvt_pk_bf16_f32 v53, v26, v27
    v_mfma_f32_32x32x16_bf16 v[112:127], v[220:223], v[60:63], v[112:127]
    v_exp_f32 v28, v28
    v_exp_f32 v29, v29
    v_exp_f32 v30, v30
    v_exp_f32 v31, v31
    v_cvt_pk_bf16_f32 v54, v28, v29
    v_cvt_pk_bf16_f32 v55, v30, v31
    v_mfma_f32_32x32x16_bf16 v[16:31], v[160:163], v[144:147], 0
    v_exp_f32 v32, v32
    v_exp_f32 v33, v33
    v_exp_f32 v34, v34
    v_exp_f32 v35, v35
    v_cvt_pk_bf16_f32 v56, v32, v33
    v_cvt_pk_bf16_f32 v57, v34, v35
    v_mfma_f32_32x32x16_bf16 v[16:31], v[164:167], v[148:151], v[16:31]
    v_exp_f32 v36, v36
    v_exp_f32 v37, v37
    v_exp_f32 v38, v38
    v_exp_f32 v39, v39
    v_cvt_pk_bf16_f32 v58, v36, v37
    v_cvt_pk_bf16_f32 v59, v38, v39
    v_mfma_f32_32x32x16_bf16 v[64:79], v[168:171], v[48:51], v[64:79]
    s_add_u32 s71, s71, 16384
    s_and_b32 s71, s71, 0x3ffff
    buffer_load_dwordx4 v[208:211], v235, s[40:43], s71 offen offset:0 sc1
    buffer_load_dwordx4 v[212:215], v235, s[40:43], s71 offen offset:1024 sc1
    buffer_load_dwordx4 v[216:219], v235, s[40:43], s71 offen offset:2048 sc1
    buffer_load_dwordx4 v[220:223], v235, s[40:43], s71 offen offset:3072 sc1
    v_exp_f32 v40, v40
    v_exp_f32 v41, v41
    v_exp_f32 v42, v42
    v_exp_f32 v43, v43
    v_cvt_pk_bf16_f32 v60, v40, v41
    v_cvt_pk_bf16_f32 v61, v42, v43
    v_mfma_f32_32x32x16_bf16 v[64:79], v[172:175], v[52:55], v[64:79]
    v_exp_f32 v44, v44
    v_exp_f32 v45, v45
    v_exp_f32 v46, v46
    v_exp_f32 v47, v47
    v_cvt_pk_bf16_f32 v62, v44, v45
    v_cvt_pk_bf16_f32 v63, v46, v47
    v_mfma_f32_32x32x16_bf16 v[32:47], v[160:163], v[152:155], 0
    v_exp_f32 v16, v16
    v_exp_f32 v17, v17
    v_exp_f32 v18, v18
    v_exp_f32 v19, v19
    v_cvt_pk_bf16_f32 v48, v16, v17
    v_cvt_pk_bf16_f32 v49, v18, v19
    v_mfma_f32_32x32x16_bf16 v[32:47], v[164:167], v[156:159], v[32:47]
    v_exp_f32 v20, v20
    v_exp_f32 v21, v21
    v_exp_f32 v22, v22
    v_exp_f32 v23, v23
    v_cvt_pk_bf16_f32 v50, v20, v21
    v_cvt_pk_bf16_f32 v51, v22, v23
    v_mfma_f32_32x32x16_bf16 v[80:95], v[168:171], v[56:59], v[80:95]
    v_exp_f32 v24, v24
    v_exp_f32 v25, v25
    v_exp_f32 v26, v26
    v_exp_f32 v27, v27
    v_cvt_pk_bf16_f32 v52, v24, v25
    v_cvt_pk_bf16_f32 v53, v26, v27
    v_mfma_f32_32x32x16_bf16 v[80:95], v[172:175], v[60:63], v[80:95]
    v_exp_f32 v28, v28
    v_exp_f32 v29, v29
    v_exp_f32 v30, v30
    v_exp_f32 v31, v31
    v_cvt_pk_bf16_f32 v54, v28, v29
    v_cvt_pk_bf16_f32 v55, v30, v31
    s_waitcnt vmcnt(8)
    v_mfma_f32_32x32x16_bf16 v[16:31], v[176:179], v[128:131], 0
    v_exp_f32 v32, v32
    v_exp_f32 v33, v33
    v_exp_f32 v34, v34
    v_exp_f32 v35, v35
    v_cvt_pk_bf16_f32 v56, v32, v33
    v_cvt_pk_bf16_f32 v57, v34, v35
    v_mfma_f32_32x32x16_bf16 v[16:31], v[180:183], v[132:135], v[16:31]
    v_exp_f32 v36, v36
    v_exp_f32 v37, v37
    v_exp_f32 v38, v38
    v_exp_f32 v39, v39
    v_cvt_pk_bf16_f32 v58, v36, v37
    v_cvt_pk_bf16_f32 v59, v38, v39
    v_mfma_f32_32x32x16_bf16 v[96:111], v[168:171], v[48:51], v[96:111]
    v_exp_f32 v40, v40
    v_exp_f32 v41, v41
    v_exp_f32 v42, v42
    v_exp_f32 v43, v43
    v_cvt_pk_bf16_f32 v60, v40, v41
    v_cvt_pk_bf16_f32 v61, v42, v43
    v_mfma_f32_32x32x16_bf16 v[96:111], v[172:175], v[52:55], v[96:111]
    v_exp_f32 v44, v44
    v_exp_f32 v45, v45
    v_exp_f32 v46, v46
    v_exp_f32 v47, v47
    v_cvt_pk_bf16_f32 v62, v44, v45
    v_cvt_pk_bf16_f32 v63, v46, v47
    v_mfma_f32_32x32x16_bf16 v[32:47], v[176:179], v[136:139], 0
    v_exp_f32 v16, v16
    v_exp_f32 v17, v17
    v_exp_f32 v18, v18
    v_exp_f32 v19, v19
    v_cvt_pk_bf16_f32 v48, v16, v17
    v_cvt_pk_bf16_f32 v49, v18, v19
    v_mfma_f32_32x32x16_bf16 v[32:47], v[180:183], v[140:143], v[32:47]
    v_exp_f32 v20, v20
    v_exp_f32 v21, v21
    v_exp_f32 v22, v22
    v_exp_f32 v23, v23
    v_cvt_pk_bf16_f32 v50, v20, v21
    v_cvt_pk_bf16_f32 v51, v22, v23
    v_mfma_f32_32x32x16_bf16 v[112:127], v[168:171], v[56:59], v[112:127]
    v_exp_f32 v24, v24
    v_exp_f32 v25, v25
    v_exp_f32 v26, v26
    v_exp_f32 v27, v27
    v_cvt_pk_bf16_f32 v52, v24, v25
    v_cvt_pk_bf16_f32 v53, v26, v27
    v_mfma_f32_32x32x16_bf16 v[112:127], v[172:175], v[60:63], v[112:127]
    v_exp_f32 v28, v28
    v_exp_f32 v29, v29
    v_exp_f32 v30, v30
    v_exp_f32 v31, v31
    v_cvt_pk_bf16_f32 v54, v28, v29
    v_cvt_pk_bf16_f32 v55, v30, v31
    s_add_u32 s97, s97, 1
    s_branch L_attn_loop
L_attn_tail:
    v_mfma_f32_32x32x16_bf16 v[16:31], v[208:211], v[144:147], 0
    v_exp_f32 v32, v32
    v_exp_f32 v33, v33
    v_exp_f32 v34, v34
    v_exp_f32 v35, v35
    v_cvt_pk_bf16_f32 v56, v32, v33
    v_cvt_pk_bf16_f32 v57, v34, v35
    v_mfma_f32_32x32x16_bf16 v[16:31], v[212:215], v[148:151], v[16:31]
    v_exp_f32 v36, v36
    v_exp_f32 v37, v37
    v_exp_f32 v38, v38
    v_exp_f32 v39, v39
    v_cvt_pk_bf16_f32 v58, v36, v37
    v_cvt_pk_bf16_f32 v59, v38, v39
    v_mfma_f32_32x32x16_bf16 v[64:79], v[216:219], v[48:51], v[64:79]
    v_exp_f32 v40, v40
    v_exp_f32 v41, v41
    v_exp_f32 v42, v42
    v_exp_f32 v43, v43
    v_cvt_pk_bf16_f32 v60, v40, v41
    v_cvt_pk_bf16_f32 v61, v42, v43
    v_mfma_f32_32x32x16_bf16 v[64:79], v[220:223], v[52:55], v[64:79]
    v_exp_f32 v44, v44
    v_exp_f32 v45, v45
    v_exp_f32 v46, v46
    v_exp_f32 v47, v47
    v_cvt_pk_bf16_f32 v62, v44, v45
    v_cvt_pk_bf16_f32 v63, v46, v47
    v_mfma_f32_32x32x16_bf16 v[32:47], v[208:211], v[152:155], 0
    v_exp_f32 v16, v16
    v_exp_f32 v17, v17
    v_exp_f32 v18, v18
    v_exp_f32 v19, v19
    v_cvt_pk_bf16_f32 v48, v16, v17
    v_cvt_pk_bf16_f32 v49, v18, v19
    v_mfma_f32_32x32x16_bf16 v[32:47], v[212:215], v[156:159], v[32:47]
    v_exp_f32 v20, v20
    v_exp_f32 v21, v21
    v_exp_f32 v22, v22
    v_exp_f32 v23, v23
    v_cvt_pk_bf16_f32 v50, v20, v21
    v_cvt_pk_bf16_f32 v51, v22, v23
    v_mfma_f32_32x32x16_bf16 v[80:95], v[216:219], v[56:59], v[80:95]
    v_exp_f32 v24, v24
    v_exp_f32 v25, v25
    v_exp_f32 v26, v26
    v_exp_f32 v27, v27
    v_cvt_pk_bf16_f32 v52, v24, v25
    v_cvt_pk_bf16_f32 v53, v26, v27
    v_mfma_f32_32x32x16_bf16 v[80:95], v[220:223], v[60:63], v[80:95]
    v_exp_f32 v28, v28
    v_exp_f32 v29, v29
    v_exp_f32 v30, v30
    v_exp_f32 v31, v31
    v_cvt_pk_bf16_f32 v54, v28, v29
    v_cvt_pk_bf16_f32 v55, v30, v31
    v_mfma_f32_32x32x16_bf16 v[96:111], v[216:219], v[48:51], v[96:111]
    v_exp_f32 v32, v32
    v_exp_f32 v33, v33
    v_exp_f32 v34, v34
    v_exp_f32 v35, v35
    v_cvt_pk_bf16_f32 v56, v32, v33
    v_cvt_pk_bf16_f32 v57, v34, v35
    v_mfma_f32_32x32x16_bf16 v[96:111], v[220:223], v[52:55], v[96:111]
    v_exp_f32 v36, v36
    v_exp_f32 v37, v37
    v_exp_f32 v38, v38
    v_exp_f32 v39, v39
    v_cvt_pk_bf16_f32 v58, v36, v37
    v_cvt_pk_bf16_f32 v59, v38, v39
    v_exp_f32 v40, v40
    v_exp_f32 v41, v41
    v_exp_f32 v42, v42
    v_exp_f32 v43, v43
    v_cvt_pk_bf16_f32 v60, v40, v41
    v_cvt_pk_bf16_f32 v61, v42, v43
    v_exp_f32 v44, v44
    v_exp_f32 v45, v45
    v_exp_f32 v46, v46
    v_exp_f32 v47, v47
    v_cvt_pk_bf16_f32 v62, v44, v45
    v_cvt_pk_bf16_f32 v63, v46, v47
    s_nop 1
    v_mfma_f32_32x32x16_bf16 v[112:127], v[216:219], v[56:59], v[112:127]
    v_mfma_f32_32x32x16_bf16 v[112:127], v[220:223], v[60:63], v[112:127]
    s_waitcnt vmcnt(0)
    s_mov_b32 s56, 729808896
    s_mov_b32 s57, 1400897536
    s_mov_b64 s[58:59], -1
    v_cmp_le_f32 vcc, s56, v64
    s_and_b64 s[58:59], s[58:59], vcc
    v_cmp_ge_f32 vcc, s57, v64
    s_and_b64 s[58:59], s[58:59], vcc
    v_cmp_le_f32 vcc, s56, v80
    s_and_b64 s[58:59], s[58:59], vcc
    v_cmp_ge_f32 vcc, s57, v80
    s_and_b64 s[58:59], s[58:59], vcc
    v_cmp_le_f32 vcc, s56, v96
    s_and_b64 s[58:59], s[58:59], vcc
    v_cmp_ge_f32 vcc, s57, v96
    s_and_b64 s[58:59], s[58:59], vcc
    v_cmp_le_f32 vcc, s56, v112
    s_and_b64 s[58:59], s[58:59], vcc
    v_cmp_ge_f32 vcc, s57, v112
    s_and_b64 s[58:59], s[58:59], vcc
    s_cmp_eq_u64 s[58:59], -1
    s_cselect_b32 s56, 0, 1
    v_mov_b32 v3, s56
    s_lshl_b32 s57, s3, 2
    s_add_u32 s57, s57, 160896
    v_mov_b32 v4, s57
    ds_write_b32 v4, v3
    s_cmp_lg_u32 s3, 0
    s_cbranch_scc1 L_red_w1
    v_add_u32 v3, 78848, v2
    ds_write_b128 v3, v[80:83] offset:0
    ds_write_b128 v3, v[84:87] offset:1024
    ds_write_b128 v3, v[88:91] offset:2048
    ds_write_b128 v3, v[92:95] offset:3072
    v_add_u32 v3, 87040, v2
    ds_write_b128 v3, v[96:99] offset:0
    ds_write_b128 v3, v[100:103] offset:1024
    ds_write_b128 v3, v[104:107] offset:2048
    ds_write_b128 v3, v[108:111] offset:3072
    v_add_u32 v3, 95232, v2
    ds_write_b128 v3, v[112:115] offset:0
    ds_write_b128 v3, v[116:119] offset:1024
    ds_write_b128 v3, v[120:123] offset:2048
    ds_write_b128 v3, v[124:127] offset:3072
    v_mov_b32 v16, v64
    v_mov_b32 v17, v65
    v_mov_b32 v18, v66
    v_mov_b32 v19, v67
    v_mov_b32 v20, v68
    v_mov_b32 v21, v69
    v_mov_b32 v22, v70
    v_mov_b32 v23, v71
    v_mov_b32 v24, v72
    v_mov_b32 v25, v73
    v_mov_b32 v26, v74
    v_mov_b32 v27, v75
    v_mov_b32 v28, v76
    v_mov_b32 v29, v77
    v_mov_b32 v30, v78
    v_mov_b32 v31, v79
    s_branch L_red_done
L_red_w1:
    s_cmp_lg_u32 s3, 1
    s_cbranch_scc1 L_red_w2
    v_add_u32 v3, 58368, v2
    ds_write_b128 v3, v[64:67] offset:0
    ds_write_b128 v3, v[68:71] offset:1024
    ds_write_b128 v3, v[72:75] offset:2048
    ds_write_b128 v3, v[76:79] offset:3072
    v_add_u32 v3, 91136, v2
    ds_write_b128 v3, v[96:99] offset:0
    ds_write_b128 v3, v[100:103] offset:1024
    ds_write_b128 v3, v[104:107] offset:2048
    ds_write_b128 v3, v[108:111] offset:3072
    v_add_u32 v3, 99328, v2
    ds_write_b128 v3, v[112:115] offset:0
    ds_write_b128 v3, v[116:119] offset:1024
    ds_write_b128 v3, v[120:123] offset:2048
    ds_write_b128 v3, v[124:127] offset:3072
    v_mov_b32 v16, v80
    v_mov_b32 v17, v81
    v_mov_b32 v18, v82
    v_mov_b32 v19, v83
    v_mov_b32 v20, v84
    v_mov_b32 v21, v85
    v_mov_b32 v22, v86
    v_mov_b32 v23, v87
    v_mov_b32 v24, v88
    v_mov_b32 v25, v89
    v_mov_b32 v26, v90
    v_mov_b32 v27, v91
    v_mov_b32 v28, v92
    v_mov_b32 v29, v93
    v_mov_b32 v30, v94
    v_mov_b32 v31, v95
    s_branch L_red_done
L_red_w2:
    s_cmp_lg_u32 s3, 2
    s_cbranch_scc1 L_red_w3
    v_add_u32 v3, 62464, v2
    ds_write_b128 v3, v[64:67] offset:0
    ds_write_b128 v3, v[68:71] offset:1024
    ds_write_b128 v3, v[72:75] offset:2048
    ds_write_b128 v3, v[76:79] offset:3072
    v_add_u32 v3, 70656, v2
    ds_write_b128 v3, v[80:83] offset:0
    ds_write_b128 v3, v[84:87] offset:1024
    ds_write_b128 v3, v[88:91] offset:2048
    ds_write_b128 v3, v[92:95] offset:3072
    v_add_u32 v3, 103424, v2
    ds_write_b128 v3, v[112:115] offset:0
    ds_write_b128 v3, v[116:119] offset:1024
    ds_write_b128 v3, v[120:123] offset:2048
    ds_write_b128 v3, v[124:127] offset:3072
    v_mov_b32 v16, v96
    v_mov_b32 v17, v97
    v_mov_b32 v18, v98
    v_mov_b32 v19, v99
    v_mov_b32 v20, v100
    v_mov_b32 v21, v101
    v_mov_b32 v22, v102
    v_mov_b32 v23, v103
    v_mov_b32 v24, v104
    v_mov_b32 v25, v105
    v_mov_b32 v26, v106
    v_mov_b32 v27, v107
    v_mov_b32 v28, v108
    v_mov_b32 v29, v109
    v_mov_b32 v30, v110
    v_mov_b32 v31, v111
    s_branch L_red_done
L_red_w3:
    v_add_u32 v3, 66560, v2
    ds_write_b128 v3, v[64:67] offset:0
    ds_write_b128 v3, v[68:71] offset:1024
    ds_write_b128 v3, v[72:75] offset:2048
    ds_write_b128 v3, v[76:79] offset:3072
    v_add_u32 v3, 74752, v2
    ds_write_b128 v3, v[80:83] offset:0
    ds_write_b128 v3, v[84:87] offset:1024
    ds_write_b128 v3, v[88:91] offset:2048
    ds_write_b128 v3, v[92:95] offset:3072
    v_add_u32 v3, 82944, v2
    ds_write_b128 v3, v[96:99] offset:0
    ds_write_b128 v3, v[100:103] offset:1024
    ds_write_b128 v3, v[104:107] offset:2048
    ds_write_b128 v3, v[108:111] offset:3072
    v_mov_b32 v16, v112
    v_mov_b32 v17, v113
    v_mov_b32 v18, v114
    v_mov_b32 v19, v115
    v_mov_b32 v20, v116
    v_mov_b32 v21, v117
    v_mov_b32 v22, v118
    v_mov_b32 v23, v119
    v_mov_b32 v24, v120
    v_mov_b32 v25, v121
    v_mov_b32 v26, v122
    v_mov_b32 v27, v123
    v_mov_b32 v28, v124
    v_mov_b32 v29, v125
    v_mov_b32 v30, v126
    v_mov_b32 v31, v127
L_red_done:
    s_waitcnt lgkmcnt(0)
    s_barrier
    v_mov_b32 v4, 160896
    ds_read_b128 v[8:11], v4
    s_mul_i32 s56, s3, 12288
    s_add_u32 s56, s56, 58368
    v_add_u32 v3, s56, v2
    ds_read_b128 v[64:67], v3 offset:0
    ds_read_b128 v[68:71], v3 offset:1024
    ds_read_b128 v[72:75], v3 offset:2048
    ds_read_b128 v[76:79], v3 offset:3072
    ds_read_b128 v[80:83], v3 offset:4096
    ds_read_b128 v[84:87], v3 offset:5120
    ds_read_b128 v[88:91], v3 offset:6144
    ds_read_b128 v[92:95], v3 offset:7168
    ds_read_b128 v[96:99], v3 offset:8192
    ds_read_b128 v[100:103], v3 offset:9216
    ds_read_b128 v[104:107], v3 offset:10240
    ds_read_b128 v[108:111], v3 offset:11264
    s_lshl_b32 s56, s49, 2
    s_add_u32 s56, s56, s3
    s_lshl_b32 s56, s56, 4
    s_add_u32 s56, s56, s48
    s_lshl_b32 s56, s56, 11
    s_add_u32 s60, s56, 8388608
    s_waitcnt lgkmcnt(12)
    v_or_b32 v8, v8, v9
    v_or3_b32 v8, v8, v10, v11
    s_nop 0
    v_readfirstlane_b32 s56, v8
    s_nop 3
    s_andn2_b32 s56, s56, s96
    s_cmp_lg_u32 s56, 0
    s_cbranch_scc1 L_slow
    s_waitcnt lgkmcnt(8)
    v_add_f32 v16, v16, v64
    v_add_f32 v17, v17, v65
    v_add_f32 v18, v18, v66
    v_add_f32 v19, v19, v67
    v_add_f32 v20, v20, v68
    v_add_f32 v21, v21, v69
    v_add_f32 v22, v22, v70
    v_add_f32 v23, v23, v71
    v_add_f32 v24, v24, v72
    v_add_f32 v25, v25, v73
    v_add_f32 v26, v26, v74
    v_add_f32 v27, v27, v75
    v_add_f32 v28, v28, v76
    v_add_f32 v29, v29, v77
    v_add_f32 v30, v30, v78
    v_add_f32 v31, v31, v79
    s_waitcnt lgkmcnt(4)
    v_add_f32 v16, v16, v80
    v_add_f32 v17, v17, v81
    v_add_f32 v18, v18, v82
    v_add_f32 v19, v19, v83
    v_add_f32 v20, v20, v84
    v_add_f32 v21, v21, v85
    v_add_f32 v22, v22, v86
    v_add_f32 v23, v23, v87
    v_add_f32 v24, v24, v88
    v_add_f32 v25, v25, v89
    v_add_f32 v26, v26, v90
    v_add_f32 v27, v27, v91
    v_add_f32 v28, v28, v92
    v_add_f32 v29, v29, v93
    v_add_f32 v30, v30, v94
    v_add_f32 v31, v31, v95
    s_waitcnt lgkmcnt(0)
    v_add_f32 v16, v16, v96
    v_add_f32 v17, v17, v97
    v_add_f32 v18, v18, v98
    v_add_f32 v19, v19, v99
    v_add_f32 v20, v20, v100
    v_add_f32 v21, v21, v101
    v_add_f32 v22, v22, v102
    v_add_f32 v23, v23, v103
    v_add_f32 v24, v24, v104
    v_add_f32 v25, v25, v105
    v_add_f32 v26, v26, v106
    v_add_f32 v27, v27, v107
    v_add_f32 v28, v28, v108
    v_add_f32 v29, v29, v109
    v_add_f32 v30, v30, v110
    v_add_f32 v31, v31, v111
    v_rcp_f32 v3, v16
    s_nop 0
    v_mul_f32 v17, v17, v3
    v_mul_f32 v18, v18, v3
    v_mul_f32 v19, v19, v3
    v_mul_f32 v20, v20, v3
    v_mul_f32 v21, v21, v3
    v_mul_f32 v22, v22, v3
    v_mul_f32 v23, v23, v3
    v_mul_f32 v25, v25, v3
    v_mul_f32 v26, v26, v3
    v_mul_f32 v27, v27, v3
    v_mul_f32 v28, v28, v3
    v_mul_f32 v29, v29, v3
    v_mul_f32 v30, v30, v3
    v_mul_f32 v31, v31, v3
    v_cvt_pk_bf16_f32 v32, 0, v17
    v_cvt_pk_bf16_f32 v33, v18, v19
    v_cvt_pk_bf16_f32 v34, v20, v21
    v_cvt_pk_bf16_f32 v35, v22, v23
    v_cvt_pk_bf16_f32 v36, 0, v25
    v_cvt_pk_bf16_f32 v37, v26, v27
    v_cvt_pk_bf16_f32 v38, v28, v29
    v_cvt_pk_bf16_f32 v39, v30, v31
    buffer_store_dwordx4 v[32:35], v2, s[40:43], s60 offen sc1
    buffer_store_dwordx4 v[36:39], v2, s[40:43], s60 offen offset:1024 sc1
    s_barrier
    s_and_b32 s59, s3, 1
    v_lshrrev_b32 v8, 5, v1
    v_mul_u32_u24 v8, 7, v8
    v_bfe_u32 v9, v1, 2, 2
    v_add_u32 v8, v8, v9
    v_bfe_u32 v9, v1, 4, 1
    v_lshlrev_b32 v9, 5, v9
    v_and_b32 v10, 3, v1
    v_lshl_add_u32 v9, v10, 3, v9
    v_add_u32 v10, 0, v8
    v_bfe_u32 v11, v10, 1, 1
    v_xor_b32 v11, s59, v11
    v_lshlrev_b32 v11, 6, v11
    v_lshl_add_u32 v10, v10, 7, v11
    v_add_u32 v12, v10, v9
    v_add_u32 v10, 14, v8
    v_bfe_u32 v11, v10, 1, 1
    v_xor_b32 v11, s59, v11
    v_lshlrev_b32 v11, 6, v11
    v_lshl_add_u32 v10, v10, 7, v11
    v_add_u32 v13, v10, v9
    s_lshr_b32 s56, s3, 1
    s_lshl_b32 s56, s56, 15
    s_add_u32 s56, s56, 58368
    v_add_u32 v15, s56, v2
    s_mul_i32 s56, s3, 2560
    s_add_u32 s56, s56, 126976
    v_and_b32 v8, 31, v1
    v_mul_u32_u24 v8, 80, v8
    v_lshrrev_b32 v9, 5, v1
    v_lshlrev_b32 v9, 3, v9
    v_add3_u32 v8, v8, v9, s56
    v_lshrrev_b32 v9, 2, v1
    v_mul_u32_u24 v10, 80, v9
    v_and_b32 v11, 3, v1
    v_lshlrev_b32 v11, 4, v11
    v_add3_u32 v10, v10, v11, s56
    s_lshl_b32 s56, s51, 6
    s_lshr_b32 s58, s3, 1
    s_lshl_b32 s58, s58, 5
    s_add_u32 s56, s56, s58
    s_mul_i32 s56, s56, 1792
    s_lshl_b32 s58, s50, 7
    s_lshl_b32 s59, s59, 6
    s_add_u32 s56, s56, s58
    s_add_u32 s56, s56, s59
    s_add_u32 s56, s56, 896
    v_mul_u32_u24 v9, 1792, v9
    v_add3_u32 v14, v9, v11, s56
    s_waitcnt vmcnt(0)
    s_lshl_b32 s56, s48, 4
    s_add_u32 s56, s56, s49
    s_lshl_b32 s56, s56, 2
    s_add_u32 s56, s56, s3
    s_lshl_b32 s56, s56, 6
    s_add_u32 s56, s56, 10682368
    v_mov_b32 v4, s52
    v_mov_b32 v5, s53
    v_mov_b32 v6, 0
    s_mov_b64 exec, 1
    buffer_store_dwordx2 v[4:5], v6, s[40:43], s56 offen sc1
    s_mov_b64 exec, -1
    s_cmp_ge_u32 s2, 224
    s_cbranch_scc1 L_finB
    s_lshr_b32 s56, s3, 1
    s_lshl_b32 s57, s51, 1
    s_add_u32 s58, s56, s57
    s_and_b32 s59, s3, 1
    s_lshl_b32 s60, s59, 9
    s_add_u32 s60, s60, s58
    v_and_b32 v7, 7, v1
    v_lshlrev_b32 v7, 6, v7
    v_add_u32 v7, s60, v7
    v_lshlrev_b32 v7, 6, v7
    v_add_u32 v7, 10682368, v7
    s_lshl_b32 s58, s58, 15
    s_lshl_b32 s60, s59, 14
    s_add_u32 s58, s58, s60
    s_add_u32 s58, s58, 8388608
    s_lshr_b32 s56, s3, 1
    s_lshl_b32 s56, s56, 15
    s_add_u32 s56, s56, s60
    s_add_u32 s56, s56, 58368
    s_mov_b32 s77, 0xff
    s_mov_b32 s97, 0x40000
L_dyn_poll:
    buffer_load_dwordx2 v[4:5], v7, s[40:43], 0 offen sc1
    s_waitcnt vmcnt(0)
    v_cmp_eq_u64 vcc, s[52:53], v[4:5]
    s_sub_u32 s97, s97, 1
    s_cselect_b32 s57, -1, vcc_lo
    s_and_b32 s57, s57, s77
    s_cbranch_scc0 L_dyn_none
L_dyn_issue:
    s_ff1_i32_b32 s60, s57
    s_bitset0_b32 s57, s60
    s_bitset0_b32 s77, s60
    s_lshl_b32 s60, s60, 11
    s_add_u32 m0, s56, s60
    s_add_u32 s61, s58, s60
    buffer_load_dwordx4 v2, s[40:43], s61 offen sc1 lds
    s_add_u32 m0, m0, 1024
    s_add_u32 s61, s61, 1024
    buffer_load_dwordx4 v2, s[40:43], s61 offen sc1 lds
    s_cmp_lg_u32 s57, 0
    s_cbranch_scc1 L_dyn_issue
    s_cmp_eq_u32 s77, 0
    s_cbranch_scc1 L_dyn_done
L_dyn_none:
    s_sleep 1
    s_branch L_dyn_poll
L_dyn_done:
    s_waitcnt vmcnt(0)
    s_barrier
    ds_read_b64_tr_b16 v[32:33], v12 offset:0
    ds_read_b64_tr_b16 v[34:35], v12 offset:512
    ds_read_b128 v[36:39], v15 offset:0
    ds_read_b64_tr_b16 v[40:41], v13 offset:0
    ds_read_b64_tr_b16 v[42:43], v13 offset:512
    ds_read_b128 v[44:47], v15 offset:1024
    ds_read_b64_tr_b16 v[48:49], v12 offset:3584
    ds_read_b64_tr_b16 v[50:51], v12 offset:4096
    ds_read_b128 v[52:55], v15 offset:2048
    ds_read_b64_tr_b16 v[56:57], v13 offset:3584
    ds_read_b64_tr_b16 v[58:59], v13 offset:4096
    ds_read_b128 v[60:63], v15 offset:3072
    s_waitcnt lgkmcnt(9)
    v_mfma_f32_32x32x16_bf16 v[16:31], v[32:35], v[36:39], 0
    ds_read_b64_tr_b16 v[32:33], v12 offset:7168
    ds_read_b64_tr_b16 v[34:35], v12 offset:7680
    ds_read_b128 v[36:39], v15 offset:4096
    s_waitcnt lgkmcnt(9)
    v_mfma_f32_32x32x16_bf16 v[16:31], v[40:43], v[44:47], v[16:31]
    ds_read_b64_tr_b16 v[40:41], v13 offset:7168
    ds_read_b64_tr_b16 v[42:43], v13 offset:7680
    ds_read_b128 v[44:47], v15 offset:5120
    s_waitcnt lgkmcnt(9)
    v_mfma_f32_32x32x16_bf16 v[16:31], v[48:51], v[52:55], v[16:31]
    ds_read_b64_tr_b16 v[48:49], v12 offset:10752
    ds_read_b64_tr_b16 v[50:51], v12 offset:11264
    ds_read_b128 v[52:55], v15 offset:6144
    s_waitcnt lgkmcnt(9)
    v_mfma_f32_32x32x16_bf16 v[16:31], v[56:59], v[60:63], v[16:31]
    ds_read_b64_tr_b16 v[56:57], v13 offset:10752
    ds_read_b64_tr_b16 v[58:59], v13 offset:11264
    ds_read_b128 v[60:63], v15 offset:7168
    s_waitcnt lgkmcnt(9)
    v_mfma_f32_32x32x16_bf16 v[16:31], v[32:35], v[36:39], v[16:31]
    ds_read_b64_tr_b16 v[32:33], v12 offset:14336
    ds_read_b64_tr_b16 v[34:35], v12 offset:14848
    ds_read_b128 v[36:39], v15 offset:8192
    s_waitcnt lgkmcnt(9)
    v_mfma_f32_32x32x16_bf16 v[16:31], v[40:43], v[44:47], v[16:31]
    ds_read_b64_tr_b16 v[40:41], v13 offset:14336
    ds_read_b64_tr_b16 v[42:43], v13 offset:14848
    ds_read_b128 v[44:47], v15 offset:9216
    s_waitcnt lgkmcnt(9)
    v_mfma_f32_32x32x16_bf16 v[16:31], v[48:51], v[52:55], v[16:31]
    ds_read_b64_tr_b16 v[48:49], v12 offset:17920
    ds_read_b64_tr_b16 v[50:51], v12 offset:18432
    ds_read_b128 v[52:55], v15 offset:10240
    s_waitcnt lgkmcnt(9)
    v_mfma_f32_32x32x16_bf16 v[16:31], v[56:59], v[60:63], v[16:31]
    ds_read_b64_tr_b16 v[56:57], v13 offset:17920
    ds_read_b64_tr_b16 v[58:59], v13 offset:18432
    ds_read_b128 v[60:63], v15 offset:11264
    s_waitcnt lgkmcnt(9)
    v_mfma_f32_32x32x16_bf16 v[16:31], v[32:35], v[36:39], v[16:31]
    ds_read_b64_tr_b16 v[32:33], v12 offset:21504
    ds_read_b64_tr_b16 v[34:35], v12 offset:22016
    ds_read_b128 v[36:39], v15 offset:12288
    s_waitcnt lgkmcnt(9)
    v_mfma_f32_32x32x16_bf16 v[16:31], v[40:43], v[44:47], v[16:31]
    ds_read_b64_tr_b16 v[40:41], v13 offset:21504
    ds_read_b64_tr_b16 v[42:43], v13 offset:22016
    ds_read_b128 v[44:47], v15 offset:13312
    s_waitcnt lgkmcnt(9)
    v_mfma_f32_32x32x16_bf16 v[16:31], v[48:51], v[52:55], v[16:31]
    ds_read_b64_tr_b16 v[48:49], v12 offset:25088
    ds_read_b64_tr_b16 v[50:51], v12 offset:25600
    ds_read_b128 v[52:55], v15 offset:14336
    s_waitcnt lgkmcnt(9)
    v_mfma_f32_32x32x16_bf16 v[16:31], v[56:59], v[60:63], v[16:31]
    ds_read_b64_tr_b16 v[56:57], v13 offset:25088
    ds_read_b64_tr_b16 v[58:59], v13 offset:25600
    ds_read_b128 v[60:63], v15 offset:15360
    s_waitcnt lgkmcnt(9)
    v_mfma_f32_32x32x16_bf16 v[16:31], v[32:35], v[36:39], v[16:31]
    ds_read_b64_tr_b16 v[32:33], v12 offset:28672
    ds_read_b64_tr_b16 v[34:35], v12 offset:29184
    ds_read_b128 v[36:39], v15 offset:16384
    s_waitcnt lgkmcnt(9)
    v_mfma_f32_32x32x16_bf16 v[16:31], v[40:43], v[44:47], v[16:31]
    ds_read_b64_tr_b16 v[40:41], v13 offset:28672
    ds_read_b64_tr_b16 v[42:43], v13 offset:29184
    ds_read_b128 v[44:47], v15 offset:17408
    s_waitcnt lgkmcnt(9)
    v_mfma_f32_32x32x16_bf16 v[16:31], v[48:51], v[52:55], v[16:31]
    ds_read_b64_tr_b16 v[48:49], v12 offset:32256
    ds_read_b64_tr_b16 v[50:51], v12 offset:32768
    ds_read_b128 v[52:55], v15 offset:18432
    s_waitcnt lgkmcnt(9)
    v_mfma_f32_32x32x16_bf16 v[16:31], v[56:59], v[60:63], v[16:31]
    ds_read_b64_tr_b16 v[56:57], v13 offset:32256
    ds_read_b64_tr_b16 v[58:59], v13 offset:32768
    ds_read_b128 v[60:63], v15 offset:19456
    s_waitcnt lgkmcnt(9)
    v_mfma_f32_32x32x16_bf16 v[16:31], v[32:35], v[36:39], v[16:31]
    ds_read_b64_tr_b16 v[32:33], v12 offset:35840
    ds_read_b64_tr_b16 v[34:35], v12 offset:36352
    ds_read_b128 v[36:39], v15 offset:20480
    s_waitcnt lgkmcnt(9)
    v_mfma_f32_32x32x16_bf16 v[16:31], v[40:43], v[44:47], v[16:31]
    ds_read_b64_tr_b16 v[40:41], v13 offset:35840
    ds_read_b64_tr_b16 v[42:43], v13 offset:36352
    ds_read_b128 v[44:47], v15 offset:21504
    s_waitcnt lgkmcnt(9)
    v_mfma_f32_32x32x16_bf16 v[16:31], v[48:51], v[52:55], v[16:31]
    ds_read_b64_tr_b16 v[48:49], v12 offset:39424
    ds_read_b64_tr_b16 v[50:51], v12 offset:39936
    ds_read_b128 v[52:55], v15 offset:22528
    s_waitcnt lgkmcnt(9)
    v_mfma_f32_32x32x16_bf16 v[16:31], v[56:59], v[60:63], v[16:31]
    ds_read_b64_tr_b16 v[56:57], v13 offset:39424
    ds_read_b64_tr_b16 v[58:59], v13 offset:39936
    ds_read_b128 v[60:63], v15 offset:23552
    s_waitcnt lgkmcnt(9)
    v_mfma_f32_32x32x16_bf16 v[16:31], v[32:35], v[36:39], v[16:31]
    ds_read_b64_tr_b16 v[32:33], v12 offset:43008
    ds_read_b64_tr_b16 v[34:35], v12 offset:43520
    ds_read_b128 v[36:39], v15 offset:24576
    s_waitcnt lgkmcnt(9)
    v_mfma_f32_32x32x16_bf16 v[16:31], v[40:43], v[44:47], v[16:31]
    ds_read_b64_tr_b16 v[40:41], v13 offset:43008
    ds_read_b64_tr_b16 v[42:43], v13 offset:43520
    ds_read_b128 v[44:47], v15 offset:25600
    s_waitcnt lgkmcnt(9)
    v_mfma_f32_32x32x16_bf16 v[16:31], v[48:51], v[52:55], v[16:31]
    ds_read_b64_tr_b16 v[48:49], v12 offset:46592
    ds_read_b64_tr_b16 v[50:51], v12 offset:47104
    ds_read_b128 v[52:55], v15 offset:26624
    s_waitcnt lgkmcnt(9)
    v_mfma_f32_32x32x16_bf16 v[16:31], v[56:59], v[60:63], v[16:31]
    ds_read_b64_tr_b16 v[56:57], v13 offset:46592
    ds_read_b64_tr_b16 v[58:59], v13 offset:47104
    ds_read_b128 v[60:63], v15 offset:27648
    s_waitcnt lgkmcnt(9)
    v_mfma_f32_32x32x16_bf16 v[16:31], v[32:35], v[36:39], v[16:31]
    ds_read_b64_tr_b16 v[32:33], v12 offset:50176
    ds_read_b64_tr_b16 v[34:35], v12 offset:50688
    ds_read_b128 v[36:39], v15 offset:28672
    s_waitcnt lgkmcnt(9)
    v_mfma_f32_32x32x16_bf16 v[16:31], v[40:43], v[44:47], v[16:31]
    ds_read_b64_tr_b16 v[40:41], v13 offset:50176
    ds_read_b64_tr_b16 v[42:43], v13 offset:50688
    ds_read_b128 v[44:47], v15 offset:29696
    s_waitcnt lgkmcnt(9)
    v_mfma_f32_32x32x16_bf16 v[16:31], v[48:51], v[52:55], v[16:31]
    ds_read_b64_tr_b16 v[48:49], v12 offset:53760
    ds_read_b64_tr_b16 v[50:51], v12 offset:54272
    ds_read_b128 v[52:55], v15 offset:30720
    s_waitcnt lgkmcnt(9)
    v_mfma_f32_32x32x16_bf16 v[16:31], v[56:59], v[60:63], v[16:31]
    ds_read_b64_tr_b16 v[56:57], v13 offset:53760
    ds_read_b64_tr_b16 v[58:59], v13 offset:54272
    ds_read_b128 v[60:63], v15 offset:31744
    s_waitcnt lgkmcnt(9)
    v_mfma_f32_32x32x16_bf16 v[16:31], v[32:35], v[36:39], v[16:31]
    s_waitcnt lgkmcnt(6)
    v_mfma_f32_32x32x16_bf16 v[16:31], v[40:43], v[44:47], v[16:31]
    s_waitcnt lgkmcnt(3)
    v_mfma_f32_32x32x16_bf16 v[16:31], v[48:51], v[52:55], v[16:31]
    s_waitcnt lgkmcnt(0)
    v_mfma_f32_32x32x16_bf16 v[16:31], v[56:59], v[60:63], v[16:31]
    s_nop 7
    s_nop 7
    v_cvt_pk_bf16_f32 v48, v16, v17
    v_cvt_pk_bf16_f32 v49, v18, v19
    v_cvt_pk_bf16_f32 v50, v20, v21
    v_cvt_pk_bf16_f32 v51, v22, v23
    v_cvt_pk_bf16_f32 v52, v24, v25
    v_cvt_pk_bf16_f32 v53, v26, v27
    v_cvt_pk_bf16_f32 v54, v28, v29
    v_cvt_pk_bf16_f32 v55, v30, v31
    ds_write_b64 v8, v[48:49] offset:0
    ds_write_b64 v8, v[50:51] offset:16
    ds_write_b64 v8, v[52:53] offset:32
    ds_write_b64 v8, v[54:55] offset:48
    s_waitcnt lgkmcnt(0)
    ds_read_b128 v[56:59], v10
    ds_read_b128 v[60:63], v10 offset:1280
    s_mov_b32 s56, 28672
    s_waitcnt lgkmcnt(1)
    buffer_store_dwordx4 v[56:59], v14, s[36:39], 0 offen
    s_waitcnt lgkmcnt(0)
    buffer_store_dwordx4 v[60:63], v14, s[36:39], s56 offen
L_finB:
L_end:
    s_endpgm
L_roleA:
    s_setprio 3
    s_sub_u32 s3, s3, 4
    s_lshl_b32 s56, s51, 6
    s_lshl_b32 s57, s3, 4
    s_add_u32 s56, s56, s57
    s_mul_i32 s56, s56, 896
    s_lshl_b32 s57, s50, 7
    s_add_u32 s56, s56, s57
    v_lshrrev_b32 v3, 3, v1
    v_mul_u32_u24 v13, 896, v3
    v_and_b32 v14, 7, v1
    v_lshl_add_u32 v15, v14, 4, v13
    v_add_u32 v5, s56, v15
    v_add_u32 v6, 7168, v5
    v_subrev_u32 v4, 7168, v5
    s_lshr_b32 s56, s3, 1
    s_lshl_b32 s57, s2, 1
    s_add_u32 s56, s56, s57
    s_lshl_b32 s56, s56, 12
    s_and_b32 s57, s3, 1
    s_lshl_b32 s57, s57, 11
    s_add_u32 s56, s56, s57
    v_add_u32 v7, s56, v2
    v_mov_b32 v60, 160912
    v_mov_b32 v61, 1
    s_mov_b32 s55, 0
    s_waitcnt lgkmcnt(0)
    s_barrier
    s_mul_i32 s56, s3, 3072
    s_add_u32 m0, s56, 128000
    s_nop 0
    buffer_load_dwordx4 v5, s[4:7], 0 offen lds
    s_add_u32 m0, s56, 129024
    s_nop 0
    buffer_load_dwordx4 v6, s[4:7], 0 offen lds
    s_add_u32 m0, s56, 126976
    s_nop 0
    buffer_load_dwordx4 v4, s[4:7], 0 offen lds
    s_lshl_b32 s56, s3, 10
    s_add_u32 m0, s56, 139264
    s_lshl_b32 s57, s50, 9
    buffer_load_dwordx4 v2, s[16:19], s57 offen lds
    buffer_load_dwordx4 v[48:51], v5, s[8:11], 0 offen
    buffer_load_dwordx4 v[52:55], v6, s[8:11], 0 offen
    s_min_u32 s56, s2, 223
    s_lshl_b32 s56, s56, 2
    s_load_dword s54, s[62:63], s56
    s_or_b32 s56, s2, s3
    s_cbranch_scc1 L_nononce
    s_memrealtime s[52:53]
    s_waitcnt lgkmcnt(0)
    s_or_b32 s52, s52, 1
    v_mov_b32 v76, s52
    v_mov_b32 v77, s53
    v_mov_b32 v78, 0
    s_mov_b64 exec, 1
    buffer_store_dwordx2 v[76:77], v78, s[44:47], 0 offen sc1
    s_mov_b64 exec, -1
L_nononce:
    v_and_b32 v14, 7, v1
    s_mul_i32 s56, s3, 2304
    s_add_u32 s56, s56, 143360
    v_lshrrev_b32 v13, 3, v1
    v_mul_u32_u24 v15, 144, v13
    v_lshl_add_u32 v15, v14, 4, v15
    v_add_u32 v140, s56, v15
    v_lshrrev_b32 v3, 4, v1
    v_lshlrev_b32 v3, 3, v3
    v_bfe_u32 v16, v1, 2, 2
    v_add_u32 v3, v3, v16
    v_mul_u32_u24 v3, 144, v3
    v_and_b32 v16, 3, v1
    v_lshlrev_b32 v16, 3, v16
    s_lshl_b32 s56, s3, 5
    s_add_u32 s56, s56, 143360
    v_add3_u32 v141, v3, v16, s56
    s_mul_i32 s56, s3, 3072
    s_add_u32 s56, s56, 126976
    v_and_b32 v16, 15, v1
    v_mul_u32_u24 v16, 144, v16
    v_and_b32 v17, 0x30, v1
    v_add3_u32 v142, v16, v17, s56
    v_add_u32 v143, s56, v15
    v_lshlrev_b32 v18, 12, v13
    v_lshl_add_u32 v144, v14, 4, v18
    s_lshl_b32 s56, s50, 6
    s_lshl_b32 s57, s3, 4
    s_add_u32 s56, s56, s57
    s_lshl_b32 s56, s56, 12
    s_lshl_b32 s57, s51, 7
    s_add_u32 s56, s56, s57
    s_add_u32 s88, s56, 4194304
    s_add_u32 s89, s88, 32768
    s_mul_i32 s56, s3, 3072
    s_add_u32 s56, s56, 126976
    v_add_u32 v3, s56, v2
    s_lshl_b32 s56, s3, 10
    s_add_u32 s56, s56, 139264
    v_and_b32 v14, 7, v1
    v_lshlrev_b32 v13, 6, v14
    v_add_u32 v13, s56, v13
    s_waitcnt vmcnt(0)
    ds_read_b128 v[124:127], v13 offset:0
    ds_read_b128 v[128:131], v13 offset:16
    ds_read_b128 v[132:135], v13 offset:32
    ds_read_b128 v[136:139], v13 offset:48
    ds_read_b128 v[16:19], v3 offset:1024
    ds_read_b128 v[20:23], v3 offset:896
    ds_read_b128 v[24:27], v3 offset:768
    ds_read_b128 v[28:31], v3 offset:640
    ds_read_b128 v[32:35], v3 offset:2048
    ds_read_b128 v[36:39], v3 offset:1920
    ds_read_b128 v[40:43], v3 offset:1792
    ds_read_b128 v[44:47], v3 offset:1664
    s_mov_b32 s56, 0x05040100
    s_mov_b32 s57, 0x07060302
    s_mov_b32 s58, 0xffff0000
    s_waitcnt lgkmcnt(4)
    v_perm_b32 v76, v20, v16, s56
    v_perm_b32 v77, v20, v16, s57
    v_perm_b32 v78, v28, v24, s56
    v_perm_b32 v79, v28, v24, s57
    v_perm_b32 v80, v21, v17, s56
    v_perm_b32 v81, v21, v17, s57
    v_perm_b32 v82, v29, v25, s56
    v_perm_b32 v83, v29, v25, s57
    v_perm_b32 v84, v22, v18, s56
    v_perm_b32 v85, v22, v18, s57
    v_perm_b32 v86, v30, v26, s56
    v_perm_b32 v87, v30, v26, s57
    v_perm_b32 v88, v23, v19, s56
    v_perm_b32 v89, v23, v19, s57
    v_perm_b32 v90, v31, v27, s56
    v_perm_b32 v91, v31, v27, s57
    v_dot2_f32_bf16 v92, v76, v124, 0
    v_dot2_f32_bf16 v93, v77, v126, 0
    v_dot2_f32_bf16 v94, v80, v128, 0
    v_dot2_f32_bf16 v95, v81, v130, 0
    v_dot2_f32_bf16 v96, v84, v132, 0
    v_dot2_f32_bf16 v97, v85, v134, 0
    v_dot2_f32_bf16 v98, v88, v136, 0
    v_dot2_f32_bf16 v99, v89, v138, 0
    v_lshlrev_b32 v100, 16, v48
    v_and_b32 v101, s58, v48
    v_lshlrev_b32 v102, 16, v49
    v_and_b32 v103, s58, v49
    v_lshlrev_b32 v104, 16, v50
    v_and_b32 v105, s58, v50
    v_lshlrev_b32 v106, 16, v51
    v_and_b32 v107, s58, v51
    v_dot2_f32_bf16 v92, v78, v125, v92
    v_dot2_f32_bf16 v93, v79, v127, v93
    v_dot2_f32_bf16 v94, v82, v129, v94
    v_dot2_f32_bf16 v95, v83, v131, v95
    v_dot2_f32_bf16 v96, v86, v133, v96
    v_dot2_f32_bf16 v97, v87, v135, v97
    v_dot2_f32_bf16 v98, v90, v137, v98
    v_dot2_f32_bf16 v99, v91, v139, v99
    s_nop 2
    v_mul_f32 v92, v92, v100
    v_mul_f32 v93, v93, v101
    v_mul_f32 v94, v94, v102
    v_mul_f32 v95, v95, v103
    v_mul_f32 v96, v96, v104
    v_mul_f32 v97, v97, v105
    v_mul_f32 v98, v98, v106
    v_mul_f32 v99, v99, v107
    v_cvt_pk_bf16_f32 v108, v92, v93
    v_cvt_pk_bf16_f32 v109, v94, v95
    v_cvt_pk_bf16_f32 v110, v96, v97
    v_cvt_pk_bf16_f32 v111, v98, v99
    s_waitcnt lgkmcnt(0)
    v_perm_b32 v76, v36, v32, s56
    v_perm_b32 v77, v36, v32, s57
    v_perm_b32 v78, v44, v40, s56
    v_perm_b32 v79, v44, v40, s57
    v_perm_b32 v80, v37, v33, s56
    v_perm_b32 v81, v37, v33, s57
    v_perm_b32 v82, v45, v41, s56
    v_perm_b32 v83, v45, v41, s57
    v_perm_b32 v84, v38, v34, s56
    v_perm_b32 v85, v38, v34, s57
    v_perm_b32 v86, v46, v42, s56
    v_perm_b32 v87, v46, v42, s57
    v_perm_b32 v88, v39, v35, s56
    v_perm_b32 v89, v39, v35, s57
    v_perm_b32 v90, v47, v43, s56
    v_perm_b32 v91, v47, v43, s57
    v_dot2_f32_bf16 v92, v76, v124, 0
    v_dot2_f32_bf16 v93, v77, v126, 0
    v_dot2_f32_bf16 v94, v80, v128, 0
    v_dot2_f32_bf16 v95, v81, v130, 0
    v_dot2_f32_bf16 v96, v84, v132, 0
    v_dot2_f32_bf16 v97, v85, v134, 0
    v_dot2_f32_bf16 v98, v88, v136, 0
    v_dot2_f32_bf16 v99, v89, v138, 0
    v_lshlrev_b32 v100, 16, v52
    v_and_b32 v101, s58, v52
    v_lshlrev_b32 v102, 16, v53
    v_and_b32 v103, s58, v53
    v_lshlrev_b32 v104, 16, v54
    v_and_b32 v105, s58, v54
    v_lshlrev_b32 v106, 16, v55
    v_and_b32 v107, s58, v55
    v_dot2_f32_bf16 v92, v78, v125, v92
    v_dot2_f32_bf16 v93, v79, v127, v93
    v_dot2_f32_bf16 v94, v82, v129, v94
    v_dot2_f32_bf16 v95, v83, v131, v95
    v_dot2_f32_bf16 v96, v86, v133, v96
    v_dot2_f32_bf16 v97, v87, v135, v97
    v_dot2_f32_bf16 v98, v90, v137, v98
    v_dot2_f32_bf16 v99, v91, v139, v99
    s_nop 2
    v_mul_f32 v92, v92, v100
    v_mul_f32 v93, v93, v101
    v_mul_f32 v94, v94, v102
    v_mul_f32 v95, v95, v103
    v_mul_f32 v96, v96, v104
    v_mul_f32 v97, v97, v105
    v_mul_f32 v98, v98, v106
    v_mul_f32 v99, v99, v107
    v_cvt_pk_bf16_f32 v112, v92, v93
    v_cvt_pk_bf16_f32 v113, v94, v95
    v_cvt_pk_bf16_f32 v114, v96, v97
    v_cvt_pk_bf16_f32 v115, v98, v99
    v_mov_b32 v242, 0
    buffer_load_dwordx2 v[240:241], v242, s[44:47], 0 offen sc1
    ds_write_b128 v140, v[108:111]
    ds_write_b128 v140, v[112:115] offset:1152
    s_add_u32 s55, s55, 4
    s_mov_b64 exec, 1
    ds_add_u32 v60, v61
    s_mov_b64 exec, -1
    s_mov_b32 s97, 0x100000
L_sw10:
    ds_read_b32 v62, v60
    s_waitcnt lgkmcnt(0)
    v_readfirstlane_b32 s95, v62
    s_cmp_ge_u32 s95, s55
    s_cbranch_scc1 L_swd10
    s_sub_u32 s97, s97, 1
    s_cbranch_scc0 L_sw10
L_swd10:
    ds_read_b64_tr_b16 v[76:77], v141 offset:0
    ds_read_b64_tr_b16 v[78:79], v141 offset:576
    ds_read_b64_tr_b16 v[80:81], v141 offset:4608
    ds_read_b64_tr_b16 v[82:83], v141 offset:5184
    s_waitcnt lgkmcnt(2)
    ds_write_b128 v142, v[76:79]
    s_waitcnt lgkmcnt(1)
    ds_write_b128 v142, v[80:83] offset:64
    s_waitcnt lgkmcnt(0)
    ds_read_b128 v[84:87], v143
    ds_read_b128 v[88:91], v143 offset:1152
    s_waitcnt lgkmcnt(1)
    buffer_store_dwordx4 v[84:87], v144, s[40:43], s88 offen sc1
    s_waitcnt lgkmcnt(0)
    buffer_store_dwordx4 v[88:91], v144, s[40:43], s89 offen sc1
    s_waitcnt vmcnt(0)
    v_readfirstlane_b32 s52, v240
    v_readfirstlane_b32 s53, v241
    s_nop 3
    s_or_b32 s56, s52, s53
    s_cbranch_scc1 L_nonce_doneA
    s_mov_b32 s97, 0x40000
L_nonceA:
    buffer_load_dwordx2 v[240:241], v242, s[44:47], 0 offen sc1
    s_waitcnt vmcnt(0)
    v_readfirstlane_b32 s52, v240
    v_readfirstlane_b32 s53, v241
    s_nop 3
    s_or_b32 s56, s52, s53
    s_cbranch_scc1 L_nonce_doneA
    s_sub_u32 s97, s97, 1
    s_cbranch_scc1 L_nonce_doneA
    s_sleep 2
    s_branch L_nonceA
L_nonce_doneA:
    s_mov_b32 s56, s2
    s_lshl_b32 s56, s56, 2
    s_add_u32 s56, s56, s3
    s_lshl_b32 s56, s56, 6
    s_add_u32 s56, s56, 10485760
    v_mov_b32 v24, s52
    v_mov_b32 v25, s53
    v_mov_b32 v26, 0
    s_mov_b64 exec, 1
    buffer_store_dwordx2 v[24:25], v26, s[40:43], s56 offen sc1
    s_mov_b64 exec, -1
    s_setprio 1
    s_cmp_ge_u32 s2, 224
    s_cbranch_scc1 L_finA
    buffer_load_dwordx4 v[116:119], v7, s[20:23], 0 offen
    buffer_load_dwordx4 v[120:123], v7, s[20:23], 0 offen offset:1024
    s_add_u32 s55, s55, 4
    s_mov_b64 exec, 1
    ds_add_u32 v60, v61
    s_mov_b64 exec, -1
    s_mov_b32 s97, 0x100000
L_sw11:
    ds_read_b32 v62, v60
    s_waitcnt lgkmcnt(0)
    v_readfirstlane_b32 s95, v62
    s_cmp_ge_u32 s95, s55
    s_cbranch_scc1 L_swd11
    s_sub_u32 s97, s97, 1
    s_cbranch_scc0 L_sw11
L_swd11:
    s_waitcnt vmcnt(0)
    s_lshr_b32 s56, s3, 1
    s_lshl_b32 s57, s54, 16
    s_and_b32 s58, s54, 0xffff0000
    s_cmp_eq_u32 s56, 0
    s_cselect_b32 s57, s57, s58
    v_lshlrev_b32 v3, 16, v116
    v_add_f32 v3, s57, v3
    v_cvt_pk_bf16_f32 v3, v3, v3
    s_mov_b32 s58, 0xffff
    v_bfi_b32 v3, s58, v3, v116
    s_and_b32 s58, s3, 1
    s_xor_b32 s60, s58, 1
    s_mov_b32 s61, 0
    v_cndmask_b32 v116, v116, v3, s[60:61]
    s_mul_i32 s57, s56, 4160
    s_add_u32 s57, s57, 152576
    v_add_u32 v13, s57, v2
    s_lshl_b32 s58, s58, 11
    s_add_u32 s58, s58, 64
    v_add_u32 v3, s58, v13
    ds_write_b128 v3, v[116:119]
    ds_write_b128 v3, v[120:123] offset:1024
    v_mov_b32 v76, 0
    v_mov_b32 v77, 0
    v_mov_b32 v78, 0
    v_mov_b32 v79, 0
    s_mul_i32 s57, s56, 5248
    s_add_u32 s57, s57, 126976
    v_add_u32 v14, s57, v2
    s_mov_b64 exec, 0xf
    ds_write_b128 v13, v[76:79]
    s_mov_b32 exec_lo, -1
    s_mov_b32 exec_hi, 0xf
    ds_write_b128 v14, v[76:79]
    s_mov_b64 exec, -1
    s_lshr_b32 s56, s3, 1
    s_and_b32 s58, s3, 1
    s_mul_i32 s57, s56, 5248
    s_mul_i32 s59, s58, 2304
    s_add_u32 s57, s57, s59
    s_add_u32 s57, s57, 127552
    v_lshrrev_b32 v3, 4, v1
    v_lshlrev_b32 v3, 5, v3
    v_add3_u32 v53, v3, v2, s57
    v_bfe_u32 v8, v1, 4, 1
    v_lshrrev_b32 v9, 5, v1
    v_bfe_u32 v10, v1, 2, 2
    v_and_b32 v11, 3, v1
    v_lshlrev_b32 v12, 2, v8
    v_add_u32 v12, v12, v11
    v_lshl_add_u32 v13, v9, 3, v12
    v_add_u32 v13, v13, v10
    s_mul_i32 s57, s56, 4160
    s_add_u32 s57, s57, 152584
    v_lshlrev_b32 v13, 3, v13
    v_add_u32 v48, s57, v13
    v_sub_u32 v12, v12, v9
    v_lshlrev_b32 v12, 5, v12
    v_lshlrev_b32 v10, 2, v10
    v_sub_u32 v12, v12, v10
    v_add_u32 v12, 28, v12
    s_mul_i32 s57, s56, 5248
    s_add_u32 s57, s57, 126976
    v_add_u32 v13, 0, v12
    v_ashrrev_i32 v14, 7, v13
    v_lshlrev_b32 v14, 5, v14
    v_lshl_add_u32 v13, v13, 1, v14
    v_add_u32 v49, s57, v13
    v_add_u32 v13, -16, v12
    v_ashrrev_i32 v14, 7, v13
    v_lshlrev_b32 v14, 5, v14
    v_lshl_add_u32 v13, v13, 1, v14
    v_add_u32 v50, s57, v13
    v_add_u32 v13, 64, v12
    v_ashrrev_i32 v14, 7, v13
    v_lshlrev_b32 v14, 5, v14
    v_lshl_add_u32 v13, v13, 1, v14
    v_add_u32 v51, s57, v13
    v_add_u32 v13, 48, v12
    v_ashrrev_i32 v14, 7, v13
    v_lshlrev_b32 v14, 5, v14
    v_lshl_add_u32 v13, v13, 1, v14
    v_add_u32 v52, s57, v13
    s_lshl_b32 s56, s2, 1
    s_bfe_u32 s56, s56, 0x20004
    s_lshl_b32 s57, s50, 5
    s_and_b32 s58, s3, 1
    s_lshl_b32 s58, s58, 4
    s_add_u32 s57, s57, s58
    s_lshl_b32 s57, s57, 2
    s_add_u32 s56, s56, s57
    v_and_b32 v7, 15, v1
    v_lshlrev_b32 v7, 2, v7
    v_add_u32 v7, s56, v7
    v_lshlrev_b32 v7, 6, v7
    v_add_u32 v7, 10485760, v7
    s_mov_b32 s97, 0x40000
L_poll_a1:
    buffer_load_dwordx2 v[4:5], v7, s[40:43], 0 offen sc1
    s_waitcnt vmcnt(0)
    v_cmp_ne_u64 vcc, s[52:53], v[4:5]
    s_cbranch_vccz L_poll_done_a1
    s_sub_u32 s97, s97, 1
    s_cbranch_scc1 L_poll_done_a1
    s_sleep 3
    s_branch L_poll_a1
L_poll_done_a1:
    s_lshr_b32 s56, s3, 1
    s_lshl_b32 s57, s2, 1
    s_add_u32 s57, s56, s57
    s_lshl_b32 s57, s57, 12
    s_and_b32 s58, s3, 1
    s_lshl_b32 s59, s58, 11
    s_add_u32 s57, s57, s59
    s_add_u32 s57, s57, 4194304
    buffer_load_dwordx4 v[16:19], v2, s[40:43], s57 offen sc1
    buffer_load_dwordx4 v[20:23], v2, s[40:43], s57 offen offset:1024 sc1
    s_waitcnt vmcnt(0)
    ds_write_b128 v53, v[16:19]
    ds_write_b128 v53, v[20:23] offset:1152
    s_add_u32 s55, s55, 4
    s_mov_b64 exec, 1
    ds_add_u32 v60, v61
    s_mov_b64 exec, -1
    s_mov_b32 s97, 0x100000
L_sw12:
    ds_read_b32 v62, v60
    s_waitcnt lgkmcnt(0)
    v_readfirstlane_b32 s95, v62
    s_cmp_ge_u32 s95, s55
    s_cbranch_scc1 L_swd12
    s_sub_u32 s97, s97, 1
    s_cbranch_scc0 L_sw12
L_swd12:
    s_and_b32 s56, s3, 1
    s_cmp_eq_u32 s56, 0
    s_cbranch_scc0 L_conv_setB
    ds_read_b64_tr_b16 v[16:17], v48 offset:0
    ds_read_b64_tr_b16 v[18:19], v48 offset:32
    ds_read_b64_tr_b16 v[140:141], v49 offset:576
    ds_read_b64_tr_b16 v[142:143], v50 offset:576
    ds_read_b64_tr_b16 v[156:157], v49 offset:1152
    ds_read_b64_tr_b16 v[158:159], v50 offset:1152
    ds_read_b64_tr_b16 v[236:237], v49 offset:4032
    ds_read_b64_tr_b16 v[238:239], v50 offset:4032
    ds_read_b64_tr_b16 v[252:253], v49 offset:4608
    ds_read_b64_tr_b16 v[254:255], v50 offset:4608
    ds_read_b64_tr_b16 v[20:21], v48 offset:128
    ds_read_b64_tr_b16 v[22:23], v48 offset:160
    ds_read_b64_tr_b16 v[136:137], v51 offset:288
    ds_read_b64_tr_b16 v[138:139], v52 offset:288
    ds_read_b64_tr_b16 v[152:153], v51 offset:864
    ds_read_b64_tr_b16 v[154:155], v52 offset:864
    ds_read_b64_tr_b16 v[232:233], v51 offset:3744
    ds_read_b64_tr_b16 v[234:235], v52 offset:3744
    ds_read_b64_tr_b16 v[248:249], v51 offset:4320
    ds_read_b64_tr_b16 v[250:251], v52 offset:4320
    ds_read_b64_tr_b16 v[24:25], v48 offset:256
    ds_read_b64_tr_b16 v[26:27], v48 offset:288
    ds_read_b64_tr_b16 v[132:133], v49 offset:288
    ds_read_b64_tr_b16 v[134:135], v50 offset:288
    s_waitcnt lgkmcnt(14)
    v_mfma_f32_32x32x16_bf16 v[64:79], v[140:143], v[16:19], 0
    v_mfma_f32_32x32x16_bf16 v[80:95], v[156:159], v[16:19], 0
    v_mfma_f32_32x32x16_bf16 v[96:111], v[236:239], v[16:19], 0
    v_mfma_f32_32x32x16_bf16 v[112:127], v[252:255], v[16:19], 0
    ds_read_b64_tr_b16 v[148:149], v49 offset:864
    ds_read_b64_tr_b16 v[150:151], v50 offset:864
    ds_read_b64_tr_b16 v[228:229], v49 offset:3744
    ds_read_b64_tr_b16 v[230:231], v50 offset:3744
    ds_read_b64_tr_b16 v[244:245], v49 offset:4320
    ds_read_b64_tr_b16 v[246:247], v50 offset:4320
    ds_read_b64_tr_b16 v[28:29], v48 offset:384
    ds_read_b64_tr_b16 v[30:31], v48 offset:416
    ds_read_b64_tr_b16 v[128:129], v51 offset:0
    ds_read_b64_tr_b16 v[130:131], v52 offset:0
    s_waitcnt lgkmcnt(14)
    v_mfma_f32_32x32x16_bf16 v[64:79], v[136:139], v[20:23], v[64:79]
    v_mfma_f32_32x32x16_bf16 v[80:95], v[152:155], v[20:23], v[80:95]
    v_mfma_f32_32x32x16_bf16 v[96:111], v[232:235], v[20:23], v[96:111]
    v_mfma_f32_32x32x16_bf16 v[112:127], v[248:251], v[20:23], v[112:127]
    ds_read_b64_tr_b16 v[144:145], v51 offset:576
    ds_read_b64_tr_b16 v[146:147], v52 offset:576
    ds_read_b64_tr_b16 v[224:225], v51 offset:3456
    ds_read_b64_tr_b16 v[226:227], v52 offset:3456
    ds_read_b64_tr_b16 v[240:241], v51 offset:4032
    ds_read_b64_tr_b16 v[242:243], v52 offset:4032
    ds_read_b64_tr_b16 v[32:33], v48 offset:512
    ds_read_b64_tr_b16 v[34:35], v48 offset:544
    ds_read_b64_tr_b16 v[220:221], v49 offset:3456
    ds_read_b64_tr_b16 v[222:223], v50 offset:3456
    s_waitcnt lgkmcnt(14)
    v_mfma_f32_32x32x16_bf16 v[64:79], v[132:135], v[24:27], v[64:79]
    v_mfma_f32_32x32x16_bf16 v[80:95], v[148:151], v[24:27], v[80:95]
    v_mfma_f32_32x32x16_bf16 v[96:111], v[228:231], v[24:27], v[96:111]
    v_mfma_f32_32x32x16_bf16 v[112:127], v[244:247], v[24:27], v[112:127]
    ds_read_b64_tr_b16 v[36:37], v48 offset:640
    ds_read_b64_tr_b16 v[38:39], v48 offset:672
    ds_read_b64_tr_b16 v[216:217], v51 offset:3168
    ds_read_b64_tr_b16 v[218:219], v52 offset:3168
    ds_read_b64_tr_b16 v[40:41], v48 offset:768
    ds_read_b64_tr_b16 v[42:43], v48 offset:800
    ds_read_b64_tr_b16 v[212:213], v49 offset:3168
    ds_read_b64_tr_b16 v[214:215], v50 offset:3168
    ds_read_b64_tr_b16 v[44:45], v48 offset:896
    ds_read_b64_tr_b16 v[46:47], v48 offset:928
    s_waitcnt lgkmcnt(14)
    v_mfma_f32_32x32x16_bf16 v[64:79], v[128:131], v[28:31], v[64:79]
    v_mfma_f32_32x32x16_bf16 v[80:95], v[144:147], v[28:31], v[80:95]
    v_mfma_f32_32x32x16_bf16 v[96:111], v[224:227], v[28:31], v[96:111]
    v_mfma_f32_32x32x16_bf16 v[112:127], v[240:243], v[28:31], v[112:127]
    ds_read_b64_tr_b16 v[208:209], v51 offset:2880
    ds_read_b64_tr_b16 v[210:211], v52 offset:2880
    ds_read_b64_tr_b16 v[16:17], v48 offset:1024
    ds_read_b64_tr_b16 v[18:19], v48 offset:1056
    s_waitcnt lgkmcnt(14)
    v_mfma_f32_32x32x16_bf16 v[80:95], v[140:143], v[32:35], v[80:95]
    v_mfma_f32_32x32x16_bf16 v[96:111], v[220:223], v[32:35], v[96:111]
    v_mfma_f32_32x32x16_bf16 v[112:127], v[236:239], v[32:35], v[112:127]
    ds_read_b64_tr_b16 v[204:205], v49 offset:2880
    ds_read_b64_tr_b16 v[206:207], v50 offset:2880
    ds_read_b64_tr_b16 v[20:21], v48 offset:1152
    ds_read_b64_tr_b16 v[22:23], v48 offset:1184
    s_waitcnt lgkmcnt(14)
    v_mfma_f32_32x32x16_bf16 v[80:95], v[136:139], v[36:39], v[80:95]
    v_mfma_f32_32x32x16_bf16 v[96:111], v[216:219], v[36:39], v[96:111]
    v_mfma_f32_32x32x16_bf16 v[112:127], v[232:235], v[36:39], v[112:127]
    ds_read_b64_tr_b16 v[200:201], v51 offset:2592
    ds_read_b64_tr_b16 v[202:203], v52 offset:2592
    ds_read_b64_tr_b16 v[24:25], v48 offset:1280
    ds_read_b64_tr_b16 v[26:27], v48 offset:1312
    s_waitcnt lgkmcnt(14)
    v_mfma_f32_32x32x16_bf16 v[80:95], v[132:135], v[40:43], v[80:95]
    v_mfma_f32_32x32x16_bf16 v[96:111], v[212:215], v[40:43], v[96:111]
    v_mfma_f32_32x32x16_bf16 v[112:127], v[228:231], v[40:43], v[112:127]
    ds_read_b64_tr_b16 v[196:197], v49 offset:2592
    ds_read_b64_tr_b16 v[198:199], v50 offset:2592
    ds_read_b64_tr_b16 v[28:29], v48 offset:1408
    ds_read_b64_tr_b16 v[30:31], v48 offset:1440
    s_waitcnt lgkmcnt(14)
    v_mfma_f32_32x32x16_bf16 v[80:95], v[128:131], v[44:47], v[80:95]
    v_mfma_f32_32x32x16_bf16 v[96:111], v[208:211], v[44:47], v[96:111]
    v_mfma_f32_32x32x16_bf16 v[112:127], v[224:227], v[44:47], v[112:127]
    ds_read_b64_tr_b16 v[192:193], v51 offset:2304
    ds_read_b64_tr_b16 v[194:195], v52 offset:2304
    ds_read_b64_tr_b16 v[32:33], v48 offset:1536
    ds_read_b64_tr_b16 v[34:35], v48 offset:1568
    s_waitcnt lgkmcnt(14)
    v_mfma_f32_32x32x16_bf16 v[96:111], v[204:207], v[16:19], v[96:111]
    v_mfma_f32_32x32x16_bf16 v[112:127], v[220:223], v[16:19], v[112:127]
    ds_read_b64_tr_b16 v[188:189], v49 offset:2304
    ds_read_b64_tr_b16 v[190:191], v50 offset:2304
    ds_read_b64_tr_b16 v[36:37], v48 offset:1664
    ds_read_b64_tr_b16 v[38:39], v48 offset:1696
    s_waitcnt lgkmcnt(14)
    v_mfma_f32_32x32x16_bf16 v[96:111], v[200:203], v[20:23], v[96:111]
    v_mfma_f32_32x32x16_bf16 v[112:127], v[216:219], v[20:23], v[112:127]
    ds_read_b64_tr_b16 v[184:185], v51 offset:2016
    ds_read_b64_tr_b16 v[186:187], v52 offset:2016
    ds_read_b64_tr_b16 v[40:41], v48 offset:1792
    ds_read_b64_tr_b16 v[42:43], v48 offset:1824
    s_waitcnt lgkmcnt(14)
    v_mfma_f32_32x32x16_bf16 v[96:111], v[196:199], v[24:27], v[96:111]
    v_mfma_f32_32x32x16_bf16 v[112:127], v[212:215], v[24:27], v[112:127]
    ds_read_b64_tr_b16 v[180:181], v49 offset:2016
    ds_read_b64_tr_b16 v[182:183], v50 offset:2016
    ds_read_b64_tr_b16 v[44:45], v48 offset:1920
    ds_read_b64_tr_b16 v[46:47], v48 offset:1952
    s_waitcnt lgkmcnt(14)
    v_mfma_f32_32x32x16_bf16 v[96:111], v[192:195], v[28:31], v[96:111]
    v_mfma_f32_32x32x16_bf16 v[112:127], v[208:211], v[28:31], v[112:127]
    ds_read_b64_tr_b16 v[176:177], v51 offset:1728
    ds_read_b64_tr_b16 v[178:179], v52 offset:1728
    ds_read_b64_tr_b16 v[16:17], v48 offset:2048
    ds_read_b64_tr_b16 v[18:19], v48 offset:2080
    s_waitcnt lgkmcnt(14)
    v_mfma_f32_32x32x16_bf16 v[96:111], v[188:191], v[32:35], v[96:111]
    v_mfma_f32_32x32x16_bf16 v[112:127], v[204:207], v[32:35], v[112:127]
    ds_read_b64_tr_b16 v[172:173], v49 offset:1728
    ds_read_b64_tr_b16 v[174:175], v50 offset:1728
    ds_read_b64_tr_b16 v[20:21], v48 offset:2176
    ds_read_b64_tr_b16 v[22:23], v48 offset:2208
    s_waitcnt lgkmcnt(14)
    v_mfma_f32_32x32x16_bf16 v[96:111], v[184:187], v[36:39], v[96:111]
    v_mfma_f32_32x32x16_bf16 v[112:127], v[200:203], v[36:39], v[112:127]
    ds_read_b64_tr_b16 v[168:169], v51 offset:1440
    ds_read_b64_tr_b16 v[170:171], v52 offset:1440
    ds_read_b64_tr_b16 v[24:25], v48 offset:2304
    ds_read_b64_tr_b16 v[26:27], v48 offset:2336
    s_waitcnt lgkmcnt(14)
    v_mfma_f32_32x32x16_bf16 v[96:111], v[180:183], v[40:43], v[96:111]
    v_mfma_f32_32x32x16_bf16 v[112:127], v[196:199], v[40:43], v[112:127]
    ds_read_b64_tr_b16 v[164:165], v49 offset:1440
    ds_read_b64_tr_b16 v[166:167], v50 offset:1440
    ds_read_b64_tr_b16 v[28:29], v48 offset:2432
    ds_read_b64_tr_b16 v[30:31], v48 offset:2464
    s_waitcnt lgkmcnt(14)
    v_mfma_f32_32x32x16_bf16 v[96:111], v[176:179], v[44:47], v[96:111]
    v_mfma_f32_32x32x16_bf16 v[112:127], v[192:195], v[44:47], v[112:127]
    ds_read_b64_tr_b16 v[160:161], v51 offset:1152
    ds_read_b64_tr_b16 v[162:163], v52 offset:1152
    ds_read_b64_tr_b16 v[32:33], v48 offset:2560
    ds_read_b64_tr_b16 v[34:35], v48 offset:2592
    s_waitcnt lgkmcnt(14)
    v_mfma_f32_32x32x16_bf16 v[96:111], v[172:175], v[16:19], v[96:111]
    v_mfma_f32_32x32x16_bf16 v[112:127], v[188:191], v[16:19], v[112:127]
    ds_read_b64_tr_b16 v[36:37], v48 offset:2688
    ds_read_b64_tr_b16 v[38:39], v48 offset:2720
    ds_read_b64_tr_b16 v[40:41], v48 offset:2816
    ds_read_b64_tr_b16 v[42:43], v48 offset:2848
    s_waitcnt lgkmcnt(14)
    v_mfma_f32_32x32x16_bf16 v[96:111], v[168:171], v[20:23], v[96:111]
    v_mfma_f32_32x32x16_bf16 v[112:127], v[184:187], v[20:23], v[112:127]
    ds_read_b64_tr_b16 v[44:45], v48 offset:2944
    ds_read_b64_tr_b16 v[46:47], v48 offset:2976
    ds_read_b64_tr_b16 v[16:17], v48 offset:3072
    ds_read_b64_tr_b16 v[18:19], v48 offset:3104
    s_waitcnt lgkmcnt(14)
    v_mfma_f32_32x32x16_bf16 v[96:111], v[164:167], v[24:27], v[96:111]
    v_mfma_f32_32x32x16_bf16 v[112:127], v[180:183], v[24:27], v[112:127]
    ds_read_b64_tr_b16 v[20:21], v48 offset:3200
    ds_read_b64_tr_b16 v[22:23], v48 offset:3232
    ds_read_b64_tr_b16 v[24:25], v48 offset:3328
    ds_read_b64_tr_b16 v[26:27], v48 offset:3360
    s_waitcnt lgkmcnt(14)
    v_mfma_f32_32x32x16_bf16 v[96:111], v[160:163], v[28:31], v[96:111]
    v_mfma_f32_32x32x16_bf16 v[112:127], v[176:179], v[28:31], v[112:127]
    ds_read_b64_tr_b16 v[28:29], v48 offset:3456
    ds_read_b64_tr_b16 v[30:31], v48 offset:3488
    s_waitcnt lgkmcnt(14)
    v_mfma_f32_32x32x16_bf16 v[96:111], v[156:159], v[32:35], v[96:111]
    v_mfma_f32_32x32x16_bf16 v[112:127], v[172:175], v[32:35], v[112:127]
    ds_read_b64_tr_b16 v[32:33], v48 offset:3584
    ds_read_b64_tr_b16 v[34:35], v48 offset:3616
    s_waitcnt lgkmcnt(14)
    v_mfma_f32_32x32x16_bf16 v[96:111], v[152:155], v[36:39], v[96:111]
    v_mfma_f32_32x32x16_bf16 v[112:127], v[168:171], v[36:39], v[112:127]
    ds_read_b64_tr_b16 v[36:37], v48 offset:3712
    ds_read_b64_tr_b16 v[38:39], v48 offset:3744
    s_waitcnt lgkmcnt(14)
    v_mfma_f32_32x32x16_bf16 v[96:111], v[148:151], v[40:43], v[96:111]
    v_mfma_f32_32x32x16_bf16 v[112:127], v[164:167], v[40:43], v[112:127]
    ds_read_b64_tr_b16 v[40:41], v48 offset:3840
    ds_read_b64_tr_b16 v[42:43], v48 offset:3872
    s_waitcnt lgkmcnt(14)
    v_mfma_f32_32x32x16_bf16 v[96:111], v[144:147], v[44:47], v[96:111]
    v_mfma_f32_32x32x16_bf16 v[112:127], v[160:163], v[44:47], v[112:127]
    ds_read_b64_tr_b16 v[44:45], v48 offset:3968
    ds_read_b64_tr_b16 v[46:47], v48 offset:4000
    s_waitcnt lgkmcnt(14)
    v_mfma_f32_32x32x16_bf16 v[96:111], v[140:143], v[16:19], v[96:111]
    v_mfma_f32_32x32x16_bf16 v[112:127], v[156:159], v[16:19], v[112:127]
    s_waitcnt lgkmcnt(12)
    v_mfma_f32_32x32x16_bf16 v[96:111], v[136:139], v[20:23], v[96:111]
    v_mfma_f32_32x32x16_bf16 v[112:127], v[152:155], v[20:23], v[112:127]
    s_waitcnt lgkmcnt(10)
    v_mfma_f32_32x32x16_bf16 v[96:111], v[132:135], v[24:27], v[96:111]
    v_mfma_f32_32x32x16_bf16 v[112:127], v[148:151], v[24:27], v[112:127]
    s_waitcnt lgkmcnt(8)
    v_mfma_f32_32x32x16_bf16 v[96:111], v[128:131], v[28:31], v[96:111]
    v_mfma_f32_32x32x16_bf16 v[112:127], v[144:147], v[28:31], v[112:127]
    s_waitcnt lgkmcnt(6)
    v_mfma_f32_32x32x16_bf16 v[112:127], v[140:143], v[32:35], v[112:127]
    s_waitcnt lgkmcnt(4)
    v_mfma_f32_32x32x16_bf16 v[112:127], v[136:139], v[36:39], v[112:127]
    s_waitcnt lgkmcnt(2)
    v_mfma_f32_32x32x16_bf16 v[112:127], v[132:135], v[40:43], v[112:127]
    s_waitcnt lgkmcnt(0)
    v_mfma_f32_32x32x16_bf16 v[112:127], v[128:131], v[44:47], v[112:127]
    s_mov_b32 s88, 0
    s_mov_b32 s89, 1
    s_mov_b32 s90, 6
    s_mov_b32 s91, 7
    s_branch L_conv_post
L_conv_setB:
    ds_read_b64_tr_b16 v[16:17], v48 offset:0
    ds_read_b64_tr_b16 v[18:19], v48 offset:32
    ds_read_b64_tr_b16 v[172:173], v49 offset:1728
    ds_read_b64_tr_b16 v[174:175], v50 offset:1728
    ds_read_b64_tr_b16 v[188:189], v49 offset:2304
    ds_read_b64_tr_b16 v[190:191], v50 offset:2304
    ds_read_b64_tr_b16 v[204:205], v49 offset:2880
    ds_read_b64_tr_b16 v[206:207], v50 offset:2880
    ds_read_b64_tr_b16 v[220:221], v49 offset:3456
    ds_read_b64_tr_b16 v[222:223], v50 offset:3456
    ds_read_b64_tr_b16 v[20:21], v48 offset:128
    ds_read_b64_tr_b16 v[22:23], v48 offset:160
    ds_read_b64_tr_b16 v[168:169], v51 offset:1440
    ds_read_b64_tr_b16 v[170:171], v52 offset:1440
    ds_read_b64_tr_b16 v[184:185], v51 offset:2016
    ds_read_b64_tr_b16 v[186:187], v52 offset:2016
    ds_read_b64_tr_b16 v[200:201], v51 offset:2592
    ds_read_b64_tr_b16 v[202:203], v52 offset:2592
    ds_read_b64_tr_b16 v[216:217], v51 offset:3168
    ds_read_b64_tr_b16 v[218:219], v52 offset:3168
    ds_read_b64_tr_b16 v[24:25], v48 offset:256
    ds_read_b64_tr_b16 v[26:27], v48 offset:288
    ds_read_b64_tr_b16 v[164:165], v49 offset:1440
    ds_read_b64_tr_b16 v[166:167], v50 offset:1440
    s_waitcnt lgkmcnt(14)
    v_mfma_f32_32x32x16_bf16 v[64:79], v[172:175], v[16:19], 0
    v_mfma_f32_32x32x16_bf16 v[80:95], v[188:191], v[16:19], 0
    v_mfma_f32_32x32x16_bf16 v[96:111], v[204:207], v[16:19], 0
    v_mfma_f32_32x32x16_bf16 v[112:127], v[220:223], v[16:19], 0
    ds_read_b64_tr_b16 v[180:181], v49 offset:2016
    ds_read_b64_tr_b16 v[182:183], v50 offset:2016
    ds_read_b64_tr_b16 v[196:197], v49 offset:2592
    ds_read_b64_tr_b16 v[198:199], v50 offset:2592
    ds_read_b64_tr_b16 v[212:213], v49 offset:3168
    ds_read_b64_tr_b16 v[214:215], v50 offset:3168
    ds_read_b64_tr_b16 v[28:29], v48 offset:384
    ds_read_b64_tr_b16 v[30:31], v48 offset:416
    ds_read_b64_tr_b16 v[160:161], v51 offset:1152
    ds_read_b64_tr_b16 v[162:163], v52 offset:1152
    s_waitcnt lgkmcnt(14)
    v_mfma_f32_32x32x16_bf16 v[64:79], v[168:171], v[20:23], v[64:79]
    v_mfma_f32_32x32x16_bf16 v[80:95], v[184:187], v[20:23], v[80:95]
    v_mfma_f32_32x32x16_bf16 v[96:111], v[200:203], v[20:23], v[96:111]
    v_mfma_f32_32x32x16_bf16 v[112:127], v[216:219], v[20:23], v[112:127]
    ds_read_b64_tr_b16 v[176:177], v51 offset:1728
    ds_read_b64_tr_b16 v[178:179], v52 offset:1728
    ds_read_b64_tr_b16 v[192:193], v51 offset:2304
    ds_read_b64_tr_b16 v[194:195], v52 offset:2304
    ds_read_b64_tr_b16 v[208:209], v51 offset:2880
    ds_read_b64_tr_b16 v[210:211], v52 offset:2880
    ds_read_b64_tr_b16 v[32:33], v48 offset:512
    ds_read_b64_tr_b16 v[34:35], v48 offset:544
    ds_read_b64_tr_b16 v[156:157], v49 offset:1152
    ds_read_b64_tr_b16 v[158:159], v50 offset:1152
    s_waitcnt lgkmcnt(14)
    v_mfma_f32_32x32x16_bf16 v[64:79], v[164:167], v[24:27], v[64:79]
    v_mfma_f32_32x32x16_bf16 v[80:95], v[180:183], v[24:27], v[80:95]
    v_mfma_f32_32x32x16_bf16 v[96:111], v[196:199], v[24:27], v[96:111]
    v_mfma_f32_32x32x16_bf16 v[112:127], v[212:215], v[24:27], v[112:127]
    ds_read_b64_tr_b16 v[36:37], v48 offset:640
    ds_read_b64_tr_b16 v[38:39], v48 offset:672
    ds_read_b64_tr_b16 v[152:153], v51 offset:864
    ds_read_b64_tr_b16 v[154:155], v52 offset:864
    ds_read_b64_tr_b16 v[40:41], v48 offset:768
    ds_read_b64_tr_b16 v[42:43], v48 offset:800
    ds_read_b64_tr_b16 v[148:149], v49 offset:864
    ds_read_b64_tr_b16 v[150:151], v50 offset:864
    ds_read_b64_tr_b16 v[44:45], v48 offset:896
    ds_read_b64_tr_b16 v[46:47], v48 offset:928
    s_waitcnt lgkmcnt(14)
    v_mfma_f32_32x32x16_bf16 v[64:79], v[160:163], v[28:31], v[64:79]
    v_mfma_f32_32x32x16_bf16 v[80:95], v[176:179], v[28:31], v[80:95]
    v_mfma_f32_32x32x16_bf16 v[96:111], v[192:195], v[28:31], v[96:111]
    v_mfma_f32_32x32x16_bf16 v[112:127], v[208:211], v[28:31], v[112:127]
    ds_read_b64_tr_b16 v[144:145], v51 offset:576
    ds_read_b64_tr_b16 v[146:147], v52 offset:576
    ds_read_b64_tr_b16 v[16:17], v48 offset:1024
    ds_read_b64_tr_b16 v[18:19], v48 offset:1056
    s_waitcnt lgkmcnt(14)
    v_mfma_f32_32x32x16_bf16 v[64:79], v[156:159], v[32:35], v[64:79]
    v_mfma_f32_32x32x16_bf16 v[80:95], v[172:175], v[32:35], v[80:95]
    v_mfma_f32_32x32x16_bf16 v[96:111], v[188:191], v[32:35], v[96:111]
    v_mfma_f32_32x32x16_bf16 v[112:127], v[204:207], v[32:35], v[112:127]
    ds_read_b64_tr_b16 v[140:141], v49 offset:576
    ds_read_b64_tr_b16 v[142:143], v50 offset:576
    ds_read_b64_tr_b16 v[20:21], v48 offset:1152
    ds_read_b64_tr_b16 v[22:23], v48 offset:1184
    s_waitcnt lgkmcnt(14)
    v_mfma_f32_32x32x16_bf16 v[64:79], v[152:155], v[36:39], v[64:79]
    v_mfma_f32_32x32x16_bf16 v[80:95], v[168:171], v[36:39], v[80:95]
    v_mfma_f32_32x32x16_bf16 v[96:111], v[184:187], v[36:39], v[96:111]
    v_mfma_f32_32x32x16_bf16 v[112:127], v[200:203], v[36:39], v[112:127]
    ds_read_b64_tr_b16 v[136:137], v51 offset:288
    ds_read_b64_tr_b16 v[138:139], v52 offset:288
    ds_read_b64_tr_b16 v[24:25], v48 offset:1280
    ds_read_b64_tr_b16 v[26:27], v48 offset:1312
    s_waitcnt lgkmcnt(14)
    v_mfma_f32_32x32x16_bf16 v[64:79], v[148:151], v[40:43], v[64:79]
    v_mfma_f32_32x32x16_bf16 v[80:95], v[164:167], v[40:43], v[80:95]
    v_mfma_f32_32x32x16_bf16 v[96:111], v[180:183], v[40:43], v[96:111]
    v_mfma_f32_32x32x16_bf16 v[112:127], v[196:199], v[40:43], v[112:127]
    ds_read_b64_tr_b16 v[132:133], v49 offset:288
    ds_read_b64_tr_b16 v[134:135], v50 offset:288
    ds_read_b64_tr_b16 v[28:29], v48 offset:1408
    ds_read_b64_tr_b16 v[30:31], v48 offset:1440
    s_waitcnt lgkmcnt(14)
    v_mfma_f32_32x32x16_bf16 v[64:79], v[144:147], v[44:47], v[64:79]
    v_mfma_f32_32x32x16_bf16 v[80:95], v[160:163], v[44:47], v[80:95]
    v_mfma_f32_32x32x16_bf16 v[96:111], v[176:179], v[44:47], v[96:111]
    v_mfma_f32_32x32x16_bf16 v[112:127], v[192:195], v[44:47], v[112:127]
    ds_read_b64_tr_b16 v[128:129], v51 offset:0
    ds_read_b64_tr_b16 v[130:131], v52 offset:0
    ds_read_b64_tr_b16 v[32:33], v48 offset:1536
    ds_read_b64_tr_b16 v[34:35], v48 offset:1568
    s_waitcnt lgkmcnt(14)
    v_mfma_f32_32x32x16_bf16 v[64:79], v[140:143], v[16:19], v[64:79]
    v_mfma_f32_32x32x16_bf16 v[80:95], v[156:159], v[16:19], v[80:95]
    v_mfma_f32_32x32x16_bf16 v[96:111], v[172:175], v[16:19], v[96:111]
    v_mfma_f32_32x32x16_bf16 v[112:127], v[188:191], v[16:19], v[112:127]
    ds_read_b64_tr_b16 v[36:37], v48 offset:1664
    ds_read_b64_tr_b16 v[38:39], v48 offset:1696
    ds_read_b64_tr_b16 v[40:41], v48 offset:1792
    ds_read_b64_tr_b16 v[42:43], v48 offset:1824
    s_waitcnt lgkmcnt(14)
    v_mfma_f32_32x32x16_bf16 v[64:79], v[136:139], v[20:23], v[64:79]
    v_mfma_f32_32x32x16_bf16 v[80:95], v[152:155], v[20:23], v[80:95]
    v_mfma_f32_32x32x16_bf16 v[96:111], v[168:171], v[20:23], v[96:111]
    v_mfma_f32_32x32x16_bf16 v[112:127], v[184:187], v[20:23], v[112:127]
    ds_read_b64_tr_b16 v[44:45], v48 offset:1920
    ds_read_b64_tr_b16 v[46:47], v48 offset:1952
    ds_read_b64_tr_b16 v[16:17], v48 offset:2048
    ds_read_b64_tr_b16 v[18:19], v48 offset:2080
    s_waitcnt lgkmcnt(14)
    v_mfma_f32_32x32x16_bf16 v[64:79], v[132:135], v[24:27], v[64:79]
    v_mfma_f32_32x32x16_bf16 v[80:95], v[148:151], v[24:27], v[80:95]
    v_mfma_f32_32x32x16_bf16 v[96:111], v[164:167], v[24:27], v[96:111]
    v_mfma_f32_32x32x16_bf16 v[112:127], v[180:183], v[24:27], v[112:127]
    ds_read_b64_tr_b16 v[20:21], v48 offset:2176
    ds_read_b64_tr_b16 v[22:23], v48 offset:2208
    ds_read_b64_tr_b16 v[24:25], v48 offset:2304
    ds_read_b64_tr_b16 v[26:27], v48 offset:2336
    s_waitcnt lgkmcnt(14)
    v_mfma_f32_32x32x16_bf16 v[64:79], v[128:131], v[28:31], v[64:79]
    v_mfma_f32_32x32x16_bf16 v[80:95], v[144:147], v[28:31], v[80:95]
    v_mfma_f32_32x32x16_bf16 v[96:111], v[160:163], v[28:31], v[96:111]
    v_mfma_f32_32x32x16_bf16 v[112:127], v[176:179], v[28:31], v[112:127]
    ds_read_b64_tr_b16 v[28:29], v48 offset:2432
    ds_read_b64_tr_b16 v[30:31], v48 offset:2464
    s_waitcnt lgkmcnt(14)
    v_mfma_f32_32x32x16_bf16 v[80:95], v[140:143], v[32:35], v[80:95]
    v_mfma_f32_32x32x16_bf16 v[96:111], v[156:159], v[32:35], v[96:111]
    v_mfma_f32_32x32x16_bf16 v[112:127], v[172:175], v[32:35], v[112:127]
    ds_read_b64_tr_b16 v[32:33], v48 offset:2560
    ds_read_b64_tr_b16 v[34:35], v48 offset:2592
    s_waitcnt lgkmcnt(14)
    v_mfma_f32_32x32x16_bf16 v[80:95], v[136:139], v[36:39], v[80:95]
    v_mfma_f32_32x32x16_bf16 v[96:111], v[152:155], v[36:39], v[96:111]
    v_mfma_f32_32x32x16_bf16 v[112:127], v[168:171], v[36:39], v[112:127]
    ds_read_b64_tr_b16 v[36:37], v48 offset:2688
    ds_read_b64_tr_b16 v[38:39], v48 offset:2720
    s_waitcnt lgkmcnt(14)
    v_mfma_f32_32x32x16_bf16 v[80:95], v[132:135], v[40:43], v[80:95]
    v_mfma_f32_32x32x16_bf16 v[96:111], v[148:151], v[40:43], v[96:111]
    v_mfma_f32_32x32x16_bf16 v[112:127], v[164:167], v[40:43], v[112:127]
    ds_read_b64_tr_b16 v[40:41], v48 offset:2816
    ds_read_b64_tr_b16 v[42:43], v48 offset:2848
    s_waitcnt lgkmcnt(14)
    v_mfma_f32_32x32x16_bf16 v[80:95], v[128:131], v[44:47], v[80:95]
    v_mfma_f32_32x32x16_bf16 v[96:111], v[144:147], v[44:47], v[96:111]
    v_mfma_f32_32x32x16_bf16 v[112:127], v[160:163], v[44:47], v[112:127]
    ds_read_b64_tr_b16 v[44:45], v48 offset:2944
    ds_read_b64_tr_b16 v[46:47], v48 offset:2976
    s_waitcnt lgkmcnt(14)
    v_mfma_f32_32x32x16_bf16 v[96:111], v[140:143], v[16:19], v[96:111]
    v_mfma_f32_32x32x16_bf16 v[112:127], v[156:159], v[16:19], v[112:127]
    s_waitcnt lgkmcnt(12)
    v_mfma_f32_32x32x16_bf16 v[96:111], v[136:139], v[20:23], v[96:111]
    v_mfma_f32_32x32x16_bf16 v[112:127], v[152:155], v[20:23], v[112:127]
    s_waitcnt lgkmcnt(10)
    v_mfma_f32_32x32x16_bf16 v[96:111], v[132:135], v[24:27], v[96:111]
    v_mfma_f32_32x32x16_bf16 v[112:127], v[148:151], v[24:27], v[112:127]
    s_waitcnt lgkmcnt(8)
    v_mfma_f32_32x32x16_bf16 v[96:111], v[128:131], v[28:31], v[96:111]
    v_mfma_f32_32x32x16_bf16 v[112:127], v[144:147], v[28:31], v[112:127]
    s_waitcnt lgkmcnt(6)
    v_mfma_f32_32x32x16_bf16 v[112:127], v[140:143], v[32:35], v[112:127]
    s_waitcnt lgkmcnt(4)
    v_mfma_f32_32x32x16_bf16 v[112:127], v[136:139], v[36:39], v[112:127]
    s_waitcnt lgkmcnt(2)
    v_mfma_f32_32x32x16_bf16 v[112:127], v[132:135], v[40:43], v[112:127]
    s_waitcnt lgkmcnt(0)
    v_mfma_f32_32x32x16_bf16 v[112:127], v[128:131], v[44:47], v[112:127]
    s_mov_b32 s88, 2
    s_mov_b32 s89, 3
    s_mov_b32 s90, 4
    s_mov_b32 s91, 5
L_conv_post:
    s_mov_b32 s68, 0
    s_mov_b32 s69, 0x80000000
    s_lshr_b32 s56, s3, 1
    s_mul_i32 s56, s56, 144
    s_add_u32 s56, s56, 137472
    s_lshl_b32 s57, s88, 4
    s_add_u32 s57, s57, s56
    v_mov_b32 v136, s57
    s_lshl_b32 s57, s89, 4
    s_add_u32 s57, s57, s56
    v_mov_b32 v137, s57
    s_lshl_b32 s57, s90, 4
    s_add_u32 s57, s57, s56
    v_mov_b32 v138, s57
    s_lshl_b32 s57, s91, 4
    s_add_u32 s57, s57, s56
    v_mov_b32 v139, s57
    v_mov_b32 v140, s56
    v_mov_b32 v141, 0
    s_nop 1
    v_add_f32_dpp v128, v79, v78 wave_ror:1 row_mask:0xf bank_mask:0xf
    v_add_f32_dpp v129, v95, v94 wave_ror:1 row_mask:0xf bank_mask:0xf
    v_add_f32_dpp v130, v111, v110 wave_ror:1 row_mask:0xf bank_mask:0xf
    v_add_f32_dpp v131, v127, v126 wave_ror:1 row_mask:0xf bank_mask:0xf
    s_nop 0
    v_add_f32_dpp v132, v128, v77 wave_ror:1 row_mask:0xf bank_mask:0xf
    v_add_f32_dpp v133, v129, v93 wave_ror:1 row_mask:0xf bank_mask:0xf
    v_add_f32_dpp v134, v130, v109 wave_ror:1 row_mask:0xf bank_mask:0xf
    v_add_f32_dpp v135, v131, v125 wave_ror:1 row_mask:0xf bank_mask:0xf
    s_mov_b64 exec, s[68:69]
    ds_write_b32 v136, v79 offset:16
    ds_write_b32 v136, v128 offset:20
    ds_write_b32 v136, v132 offset:24
    ds_write_b32 v137, v95 offset:16
    ds_write_b32 v137, v129 offset:20
    ds_write_b32 v137, v133 offset:24
    ds_write_b32 v138, v111 offset:16
    ds_write_b32 v138, v130 offset:20
    ds_write_b32 v138, v134 offset:24
    ds_write_b32 v139, v127 offset:16
    ds_write_b32 v139, v131 offset:20
    ds_write_b32 v139, v135 offset:24
    ds_write_b32 v140, v141
    ds_write_b32 v140, v141 offset:4
    ds_write_b32 v140, v141 offset:8
    s_mov_b64 exec, -1
    s_add_u32 s55, s55, 4
    s_mov_b64 exec, 1
    ds_add_u32 v60, v61
    s_mov_b64 exec, -1
    s_mov_b32 s97, 0x100000
L_sw13:
    ds_read_b32 v62, v60
    s_waitcnt lgkmcnt(0)
    v_readfirstlane_b32 s95, v62
    s_cmp_ge_u32 s95, s55
    s_cbranch_scc1 L_swd13
    s_sub_u32 s97, s97, 1
    s_cbranch_scc0 L_sw13
L_swd13:
    ds_read_b32 v144, v136
    ds_read_b32 v148, v136 offset:4
    ds_read_b32 v152, v136 offset:8
    ds_read_b32 v145, v137
    ds_read_b32 v149, v137 offset:4
    ds_read_b32 v153, v137 offset:8
    ds_read_b32 v146, v138
    ds_read_b32 v150, v138 offset:4
    ds_read_b32 v154, v138 offset:8
    ds_read_b32 v147, v139
    ds_read_b32 v151, v139 offset:4
    ds_read_b32 v155, v139 offset:8
    s_lshr_b32 s56, s3, 1
    s_mul_i32 s56, s56, 5248
    s_add_u32 s56, s56, 126976
    v_lshlrev_b32 v3, 1, v1
    s_lshl_b32 s57, s88, 9
    s_add_u32 s57, s57, s56
    v_add_u32 v140, s57, v3
    s_lshl_b32 s57, s89, 9
    s_add_u32 s57, s57, s56
    v_add_u32 v141, s57, v3
    s_lshl_b32 s57, s90, 9
    s_add_u32 s57, s57, s56
    v_add_u32 v142, s57, v3
    s_lshl_b32 s57, s91, 9
    s_add_u32 s57, s57, s56
    v_add_u32 v143, s57, v3
    s_waitcnt lgkmcnt(0)
    v_cndmask_b32 v156, v67, v144, s[68:69]
    v_cndmask_b32 v157, v83, v145, s[68:69]
    v_cndmask_b32 v158, v99, v146, s[68:69]
    v_cndmask_b32 v159, v115, v147, s[68:69]
    v_add_f32_dpp v160, v156, v66 wave_ror:1 row_mask:0xf bank_mask:0xf
    v_add_f32_dpp v161, v157, v82 wave_ror:1 row_mask:0xf bank_mask:0xf
    v_add_f32_dpp v162, v158, v98 wave_ror:1 row_mask:0xf bank_mask:0xf
    v_add_f32_dpp v163, v159, v114 wave_ror:1 row_mask:0xf bank_mask:0xf
    v_cndmask_b32 v156, v160, v148, s[68:69]
    v_cndmask_b32 v157, v161, v149, s[68:69]
    v_cndmask_b32 v158, v162, v150, s[68:69]
    v_cndmask_b32 v159, v163, v151, s[68:69]
    v_add_f32_dpp v168, v156, v65 wave_ror:1 row_mask:0xf bank_mask:0xf
    v_add_f32_dpp v169, v157, v81 wave_ror:1 row_mask:0xf bank_mask:0xf
    v_add_f32_dpp v170, v158, v97 wave_ror:1 row_mask:0xf bank_mask:0xf
    v_add_f32_dpp v171, v159, v113 wave_ror:1 row_mask:0xf bank_mask:0xf
    v_cndmask_b32 v156, v168, v152, s[68:69]
    v_cndmask_b32 v157, v169, v153, s[68:69]
    v_cndmask_b32 v158, v170, v154, s[68:69]
    v_cndmask_b32 v159, v171, v155, s[68:69]
    v_add_f32_dpp v64, v156, v64 wave_ror:1 row_mask:0xf bank_mask:0xf
    v_add_f32_dpp v80, v157, v80 wave_ror:1 row_mask:0xf bank_mask:0xf
    v_add_f32_dpp v96, v158, v96 wave_ror:1 row_mask:0xf bank_mask:0xf
    v_add_f32_dpp v112, v159, v112 wave_ror:1 row_mask:0xf bank_mask:0xf
    v_cndmask_b32 v156, v71, v67, s[68:69]
    v_cndmask_b32 v157, v87, v83, s[68:69]
    v_cndmask_b32 v158, v103, v99, s[68:69]
    v_cndmask_b32 v159, v119, v115, s[68:69]
    v_add_f32_dpp v164, v156, v70 wave_ror:1 row_mask:0xf bank_mask:0xf
    v_add_f32_dpp v165, v157, v86 wave_ror:1 row_mask:0xf bank_mask:0xf
    v_add_f32_dpp v166, v158, v102 wave_ror:1 row_mask:0xf bank_mask:0xf
    v_add_f32_dpp v167, v159, v118 wave_ror:1 row_mask:0xf bank_mask:0xf
    v_cndmask_b32 v156, v164, v160, s[68:69]
    v_cndmask_b32 v157, v165, v161, s[68:69]
    v_cndmask_b32 v158, v166, v162, s[68:69]
    v_cndmask_b32 v159, v167, v163, s[68:69]
    v_add_f32_dpp v172, v156, v69 wave_ror:1 row_mask:0xf bank_mask:0xf
    v_add_f32_dpp v173, v157, v85 wave_ror:1 row_mask:0xf bank_mask:0xf
    v_add_f32_dpp v174, v158, v101 wave_ror:1 row_mask:0xf bank_mask:0xf
    v_add_f32_dpp v175, v159, v117 wave_ror:1 row_mask:0xf bank_mask:0xf
    v_cndmask_b32 v156, v172, v168, s[68:69]
    v_cndmask_b32 v157, v173, v169, s[68:69]
    v_cndmask_b32 v158, v174, v170, s[68:69]
    v_cndmask_b32 v159, v175, v171, s[68:69]
    v_add_f32_dpp v68, v156, v68 wave_ror:1 row_mask:0xf bank_mask:0xf
    v_add_f32_dpp v84, v157, v84 wave_ror:1 row_mask:0xf bank_mask:0xf
    v_add_f32_dpp v100, v158, v100 wave_ror:1 row_mask:0xf bank_mask:0xf
    v_add_f32_dpp v116, v159, v116 wave_ror:1 row_mask:0xf bank_mask:0xf
    v_cvt_pk_bf16_f32 v128, v64, v68
    v_cvt_pk_bf16_f32 v130, v80, v84
    v_cvt_pk_bf16_f32 v132, v96, v100
    v_cvt_pk_bf16_f32 v134, v112, v116
    ds_write_b16 v140, v128 offset:0
    ds_write_b16_d16_hi v140, v128 offset:128
    ds_write_b16 v141, v130 offset:0
    ds_write_b16_d16_hi v141, v130 offset:128
    ds_write_b16 v142, v132 offset:0
    ds_write_b16_d16_hi v142, v132 offset:128
    ds_write_b16 v143, v134 offset:0
    ds_write_b16_d16_hi v143, v134 offset:128
    v_cndmask_b32 v156, v75, v71, s[68:69]
    v_cndmask_b32 v157, v91, v87, s[68:69]
    v_cndmask_b32 v158, v107, v103, s[68:69]
    v_cndmask_b32 v159, v123, v119, s[68:69]
    v_add_f32_dpp v160, v156, v74 wave_ror:1 row_mask:0xf bank_mask:0xf
    v_add_f32_dpp v161, v157, v90 wave_ror:1 row_mask:0xf bank_mask:0xf
    v_add_f32_dpp v162, v158, v106 wave_ror:1 row_mask:0xf bank_mask:0xf
    v_add_f32_dpp v163, v159, v122 wave_ror:1 row_mask:0xf bank_mask:0xf
    v_cndmask_b32 v156, v160, v164, s[68:69]
    v_cndmask_b32 v157, v161, v165, s[68:69]
    v_cndmask_b32 v158, v162, v166, s[68:69]
    v_cndmask_b32 v159, v163, v167, s[68:69]
    v_add_f32_dpp v168, v156, v73 wave_ror:1 row_mask:0xf bank_mask:0xf
    v_add_f32_dpp v169, v157, v89 wave_ror:1 row_mask:0xf bank_mask:0xf
    v_add_f32_dpp v170, v158, v105 wave_ror:1 row_mask:0xf bank_mask:0xf
    v_add_f32_dpp v171, v159, v121 wave_ror:1 row_mask:0xf bank_mask:0xf
    v_cndmask_b32 v156, v168, v172, s[68:69]
    v_cndmask_b32 v157, v169, v173, s[68:69]
    v_cndmask_b32 v158, v170, v174, s[68:69]
    v_cndmask_b32 v159, v171, v175, s[68:69]
    v_add_f32_dpp v72, v156, v72 wave_ror:1 row_mask:0xf bank_mask:0xf
    v_add_f32_dpp v88, v157, v88 wave_ror:1 row_mask:0xf bank_mask:0xf
    v_add_f32_dpp v104, v158, v104 wave_ror:1 row_mask:0xf bank_mask:0xf
    v_add_f32_dpp v120, v159, v120 wave_ror:1 row_mask:0xf bank_mask:0xf
    v_cndmask_b32 v156, v79, v75, s[68:69]
    v_cndmask_b32 v157, v95, v91, s[68:69]
    v_cndmask_b32 v158, v111, v107, s[68:69]
    v_cndmask_b32 v159, v127, v123, s[68:69]
    v_add_f32_dpp v164, v156, v78 wave_ror:1 row_mask:0xf bank_mask:0xf
    v_add_f32_dpp v165, v157, v94 wave_ror:1 row_mask:0xf bank_mask:0xf
    v_add_f32_dpp v166, v158, v110 wave_ror:1 row_mask:0xf bank_mask:0xf
    v_add_f32_dpp v167, v159, v126 wave_ror:1 row_mask:0xf bank_mask:0xf
    v_cndmask_b32 v156, v164, v160, s[68:69]
    v_cndmask_b32 v157, v165, v161, s[68:69]
    v_cndmask_b32 v158, v166, v162, s[68:69]
    v_cndmask_b32 v159, v167, v163, s[68:69]
    v_add_f32_dpp v172, v156, v77 wave_ror:1 row_mask:0xf bank_mask:0xf
    v_add_f32_dpp v173, v157, v93 wave_ror:1 row_mask:0xf bank_mask:0xf
    v_add_f32_dpp v174, v158, v109 wave_ror:1 row_mask:0xf bank_mask:0xf
    v_add_f32_dpp v175, v159, v125 wave_ror:1 row_mask:0xf bank_mask:0xf
    v_cndmask_b32 v156, v172, v168, s[68:69]
    v_cndmask_b32 v157, v173, v169, s[68:69]
    v_cndmask_b32 v158, v174, v170, s[68:69]
    v_cndmask_b32 v159, v175, v171, s[68:69]
    v_add_f32_dpp v76, v156, v76 wave_ror:1 row_mask:0xf bank_mask:0xf
    v_add_f32_dpp v92, v157, v92 wave_ror:1 row_mask:0xf bank_mask:0xf
    v_add_f32_dpp v108, v158, v108 wave_ror:1 row_mask:0xf bank_mask:0xf
    v_add_f32_dpp v124, v159, v124 wave_ror:1 row_mask:0xf bank_mask:0xf
    v_cvt_pk_bf16_f32 v129, v72, v76
    v_cvt_pk_bf16_f32 v131, v88, v92
    v_cvt_pk_bf16_f32 v133, v104, v108
    v_cvt_pk_bf16_f32 v135, v120, v124
    ds_write_b16 v140, v129 offset:256
    ds_write_b16_d16_hi v140, v129 offset:384
    ds_write_b16 v141, v131 offset:256
    ds_write_b16_d16_hi v141, v131 offset:384
    ds_write_b16 v142, v133 offset:256
    ds_write_b16_d16_hi v142, v133 offset:384
    ds_write_b16 v143, v135 offset:256
    ds_write_b16_d16_hi v143, v135 offset:384
    s_lshr_b32 s58, s3, 1
    s_lshl_b32 s59, s2, 1
    s_add_u32 s59, s59, s58
    s_lshl_b32 s59, s59, 12
    s_add_u32 s59, s59, 6291456
    s_lshl_b32 s57, s88, 9
    s_add_u32 s60, s57, s59
    s_add_u32 s57, s57, s56
    v_add_u32 v144, s57, v2
    s_lshl_b32 s57, s90, 9
    s_add_u32 s61, s57, s59
    s_add_u32 s57, s57, s56
    v_add_u32 v145, s57, v2
    s_waitcnt lgkmcnt(0)
    ds_read_b128 v[160:163], v144
    ds_read_b128 v[164:167], v145
    s_waitcnt lgkmcnt(1)
    buffer_store_dwordx4 v[160:163], v2, s[40:43], s60 offen sc1
    s_waitcnt lgkmcnt(0)
    buffer_store_dwordx4 v[164:167], v2, s[40:43], s61 offen sc1
    s_waitcnt vmcnt(0)
    s_mov_b32 s56, s2
    s_lshl_b32 s56, s56, 2
    s_add_u32 s56, s56, s3
    s_lshl_b32 s56, s56, 6
    s_add_u32 s56, s56, 10616832
    v_mov_b32 v4, s52
    v_mov_b32 v5, s53
    v_mov_b32 v6, 0
    s_mov_b64 exec, 1
    buffer_store_dwordx2 v[4:5], v6, s[40:43], s56 offen sc1
    s_mov_b64 exec, -1
    s_setprio 0
    v_lshrrev_b32 v3, 3, v1
    v_mul_u32_u24 v3, 896, v3
    v_bfe_u32 v13, v1, 2, 1
    v_bfe_u32 v14, v1, 4, 1
    v_xor_b32 v13, v13, v14
    v_lshlrev_b32 v13, 6, v13
    v_and_b32 v14, 3, v1
    v_lshlrev_b32 v14, 4, v14
    v_add3_u32 v3, v3, v13, v14
    s_lshl_b32 s56, s50, 7
    v_add_u32 v58, s56, v3
    v_mov_b32 v4, 160920
    s_mov_b32 s97, 0x100000
L_sw14:
    ds_read_b32 v62, v4
    s_waitcnt lgkmcnt(0)
    v_readfirstlane_b32 s95, v62
    s_cmp_ge_u32 s95, 4
    s_cbranch_scc1 L_swd14
    s_sleep 8
    s_sub_u32 s97, s97, 1
    s_cbranch_scc0 L_sw14
L_swd14:
    s_cmp_eq_u32 s3, 0
    s_cselect_b32 s58, 896, 0
    v_subrev_u32 v4, s58, v58
    s_mul_i32 s57, s3, 7168
    s_sub_u32 s57, s57, 896
    s_max_i32 s57, s57, 0
    s_lshl_b32 s56, s3, 10
    s_add_u32 m0, s56, 0
    s_nop 0
    buffer_load_dwordx4 v4, s[32:35], s57 offen lds
    s_mov_b32 m0, 57344
    s_mov_b32 s57, 400512
    buffer_load_dwordx4 v58, s[32:35], s57 offen lds
    s_lshl_b32 s81, s3, 10
    s_add_u32 s81, s81, 0
    s_mul_i32 s87, s3, 7168
    s_sub_u32 s87, s87, 896
    s_waitcnt vmcnt(1)
    s_add_u32 s81, s81, 4096
    s_add_u32 s87, s87, 28672
    s_mov_b32 m0, s81
    s_nop 0
    buffer_load_dwordx4 v58, s[32:35], s87 offen lds
    s_waitcnt vmcnt(1)
    s_add_u32 s81, s81, 4096
    s_add_u32 s87, s87, 28672
    s_mov_b32 m0, s81
    s_nop 0
    buffer_load_dwordx4 v58, s[32:35], s87 offen lds
    s_waitcnt vmcnt(1)
    s_add_u32 s81, s81, 4096
    s_add_u32 s87, s87, 28672
    s_mov_b32 m0, s81
    s_nop 0
    buffer_load_dwordx4 v58, s[32:35], s87 offen lds
    s_waitcnt vmcnt(1)
    s_add_u32 s81, s81, 4096
    s_add_u32 s87, s87, 28672
    s_mov_b32 m0, s81
    s_nop 0
    buffer_load_dwordx4 v58, s[32:35], s87 offen lds
    s_waitcnt vmcnt(1)
    s_add_u32 s81, s81, 4096
    s_add_u32 s87, s87, 28672
    s_mov_b32 m0, s81
    s_nop 0
    buffer_load_dwordx4 v58, s[32:35], s87 offen lds
    s_waitcnt vmcnt(1)
    s_add_u32 s81, s81, 4096
    s_add_u32 s87, s87, 28672
    s_mov_b32 m0, s81
    s_nop 0
    buffer_load_dwordx4 v58, s[32:35], s87 offen lds
    s_waitcnt vmcnt(1)
    s_add_u32 s81, s81, 4096
    s_add_u32 s87, s87, 28672
    s_mov_b32 m0, s81
    s_nop 0
    buffer_load_dwordx4 v58, s[32:35], s87 offen lds
    s_waitcnt vmcnt(1)
    s_add_u32 s81, s81, 4096
    s_add_u32 s87, s87, 28672
    s_mov_b32 m0, s81
    s_nop 0
    buffer_load_dwordx4 v58, s[32:35], s87 offen lds
    s_waitcnt vmcnt(1)
    s_add_u32 s81, s81, 4096
    s_add_u32 s87, s87, 28672
    s_mov_b32 m0, s81
    s_nop 0
    buffer_load_dwordx4 v58, s[32:35], s87 offen lds
    s_waitcnt vmcnt(1)
    s_add_u32 s81, s81, 4096
    s_add_u32 s87, s87, 28672
    s_mov_b32 m0, s81
    s_nop 0
    buffer_load_dwordx4 v58, s[32:35], s87 offen lds
    s_waitcnt vmcnt(1)
    s_add_u32 s81, s81, 4096
    s_add_u32 s87, s87, 28672
    s_mov_b32 m0, s81
    s_nop 0
    buffer_load_dwordx4 v58, s[32:35], s87 offen lds
    s_waitcnt vmcnt(1)
    s_add_u32 s81, s81, 4096
    s_add_u32 s87, s87, 28672
    s_mov_b32 m0, s81
    s_nop 0
    buffer_load_dwordx4 v58, s[32:35], s87 offen lds
    s_waitcnt vmcnt(1)
    s_add_u32 s81, s81, 4096
    s_add_u32 s87, s87, 28672
    s_mov_b32 m0, s81
    s_nop 0
    buffer_load_dwordx4 v58, s[32:35], s87 offen lds
    s_lshl_b32 s56, s51, 6
    s_lshl_b32 s57, s3, 4
    s_add_u32 s56, s56, s57
    s_mul_i32 s57, s56, 896
    s_mul_i32 s58, s56, 1792
    s_lshl_b32 s59, s50, 7
    s_add_u32 s57, s57, s59
    s_add_u32 s58, s58, s59
    v_lshrrev_b32 v3, 3, v1
    v_and_b32 v13, 7, v1
    v_lshlrev_b32 v13, 4, v13
    v_mul_u32_u24 v14, 896, v3
    v_add3_u32 v56, v14, v13, s57
    v_mul_u32_u24 v14, 1792, v3
    v_add3_u32 v57, v14, v13, s58
    buffer_load_dwordx4 v[40:43], v56, s[12:15], 0 offen
    s_mov_b32 s57, 7168
    buffer_load_dwordx4 v[44:47], v56, s[12:15], s57 offen
    s_lshr_b32 s56, s51, 2
    s_add_u32 s56, s56, 2
    s_and_b32 s56, s56, 7
    s_lshr_b32 s56, s56, 2
    s_lshl_b32 s57, s50, 6
    s_lshl_b32 s58, s3, 4
    s_add_u32 s57, s57, s58
    v_and_b32 v7, 15, v1
    v_add_u32 v7, s57, v7
    v_lshrrev_b32 v8, 1, v7
    v_and_b32 v7, 1, v7
    v_lshlrev_b32 v7, 1, v7
    v_lshl_add_u32 v7, v8, 2, v7
    v_add_u32 v7, s56, v7
    v_lshlrev_b32 v7, 6, v7
    v_add_u32 v7, 10616832, v7
    s_mov_b32 s97, 0x40000
L_poll_a2:
    buffer_load_dwordx2 v[8:9], v7, s[40:43], 0 offen sc1
    s_waitcnt vmcnt(0)
    v_cmp_ne_u64 vcc, s[52:53], v[8:9]
    s_cbranch_vccz L_poll_done_a2
    s_sub_u32 s97, s97, 1
    s_cbranch_scc1 L_poll_done_a2
    s_sleep 3
    s_branch L_poll_a2
L_poll_done_a2:
    s_lshl_b32 s56, s50, 6
    s_lshl_b32 s57, s3, 4
    s_add_u32 s56, s56, s57
    s_lshl_b32 s56, s56, 12
    s_lshl_b32 s57, s51, 7
    s_add_u32 s56, s56, s57
    s_add_u32 s56, s56, 6291456
    s_add_u32 s57, s56, 32768
    v_lshrrev_b32 v3, 3, v1
    v_lshlrev_b32 v13, 12, v3
    v_and_b32 v14, 7, v1
    v_lshl_add_u32 v13, v14, 4, v13
    buffer_load_dwordx4 v[24:27], v13, s[40:43], s56 offen sc1
    buffer_load_dwordx4 v[28:31], v13, s[40:43], s57 offen sc1
    v_mul_u32_u24 v3, 144, v3
    v_lshl_add_u32 v15, v14, 4, v3
    s_mul_i32 s56, s3, 2304
    s_add_u32 s57, s56, 139264
    v_add_u32 v3, s57, v15
    s_add_u32 s57, s56, 126976
    v_add_u32 v12, s57, v15
    v_and_b32 v8, 15, v1
    v_mul_u32_u24 v8, 144, v8
    v_and_b32 v9, 0x30, v1
    v_add3_u32 v8, v8, v9, s57
    v_lshrrev_b32 v13, 4, v1
    v_lshlrev_b32 v13, 3, v13
    v_bfe_u32 v14, v1, 2, 2
    v_add_u32 v13, v13, v14
    v_mul_u32_u24 v13, 144, v13
    v_and_b32 v14, 3, v1
    v_lshlrev_b32 v14, 3, v14
    s_lshl_b32 s56, s3, 5
    s_add_u32 s56, s56, 139264
    v_add3_u32 v13, v13, v14, s56
    s_waitcnt vmcnt(0)
    ds_write_b128 v3, v[24:27]
    ds_write_b128 v3, v[28:31] offset:1152
    s_add_u32 s55, s55, 4
    s_mov_b64 exec, 1
    ds_add_u32 v60, v61
    s_mov_b64 exec, -1
    s_mov_b32 s97, 0x100000
L_sw15:
    ds_read_b32 v62, v60
    s_waitcnt lgkmcnt(0)
    v_readfirstlane_b32 s95, v62
    s_cmp_ge_u32 s95, s55
    s_cbranch_scc1 L_swd15
    s_sub_u32 s97, s97, 1
    s_cbranch_scc0 L_sw15
L_swd15:
    ds_read_b64_tr_b16 v[16:17], v13 offset:0
    ds_read_b64_tr_b16 v[18:19], v13 offset:576
    ds_read_b64_tr_b16 v[20:21], v13 offset:4608
    ds_read_b64_tr_b16 v[22:23], v13 offset:5184
    s_waitcnt lgkmcnt(2)
    ds_write_b128 v8, v[16:19]
    s_waitcnt lgkmcnt(1)
    ds_write_b128 v8, v[20:23] offset:64
    s_waitcnt lgkmcnt(0)
    ds_read_b128 v[16:19], v12
    ds_read_b128 v[20:23], v12 offset:1152
    s_mov_b32 s56, 0xffff0000
    s_waitcnt lgkmcnt(0)
    v_lshlrev_b32 v24, 16, v16
    v_and_b32 v25, s56, v16
    v_lshlrev_b32 v26, 16, v40
    v_and_b32 v27, s56, v40
    v_mul_f32 v24, v24, v26
    v_mul_f32 v25, v25, v27
    v_cvt_pk_bf16_f32 v32, v24, v25
    v_lshlrev_b32 v24, 16, v17
    v_and_b32 v25, s56, v17
    v_lshlrev_b32 v26, 16, v41
    v_and_b32 v27, s56, v41
    v_mul_f32 v24, v24, v26
    v_mul_f32 v25, v25, v27
    v_cvt_pk_bf16_f32 v33, v24, v25
    v_lshlrev_b32 v24, 16, v18
    v_and_b32 v25, s56, v18
    v_lshlrev_b32 v26, 16, v42
    v_and_b32 v27, s56, v42
    v_mul_f32 v24, v24, v26
    v_mul_f32 v25, v25, v27
    v_cvt_pk_bf16_f32 v34, v24, v25
    v_lshlrev_b32 v24, 16, v19
    v_and_b32 v25, s56, v19
    v_lshlrev_b32 v26, 16, v43
    v_and_b32 v27, s56, v43
    v_mul_f32 v24, v24, v26
    v_mul_f32 v25, v25, v27
    v_cvt_pk_bf16_f32 v35, v24, v25
    v_lshlrev_b32 v24, 16, v20
    v_and_b32 v25, s56, v20
    v_lshlrev_b32 v26, 16, v44
    v_and_b32 v27, s56, v44
    v_mul_f32 v24, v24, v26
    v_mul_f32 v25, v25, v27
    v_cvt_pk_bf16_f32 v36, v24, v25
    v_lshlrev_b32 v24, 16, v21
    v_and_b32 v25, s56, v21
    v_lshlrev_b32 v26, 16, v45
    v_and_b32 v27, s56, v45
    v_mul_f32 v24, v24, v26
    v_mul_f32 v25, v25, v27
    v_cvt_pk_bf16_f32 v37, v24, v25
    v_lshlrev_b32 v24, 16, v22
    v_and_b32 v25, s56, v22
    v_lshlrev_b32 v26, 16, v46
    v_and_b32 v27, s56, v46
    v_mul_f32 v24, v24, v26
    v_mul_f32 v25, v25, v27
    v_cvt_pk_bf16_f32 v38, v24, v25
    v_lshlrev_b32 v24, 16, v23
    v_and_b32 v25, s56, v23
    v_lshlrev_b32 v26, 16, v47
    v_and_b32 v27, s56, v47
    v_mul_f32 v24, v24, v26
    v_mul_f32 v25, v25, v27
    v_cvt_pk_bf16_f32 v39, v24, v25
    buffer_store_dwordx4 v[32:35], v57, s[36:39], 0 offen
    s_mov_b32 s56, 14336
    buffer_store_dwordx4 v[36:39], v57, s[36:39], s56 offen
    s_waitcnt vmcnt(0)
L_finA:
    s_endpgm
L_slow:
    s_waitcnt vmcnt(0) lgkmcnt(0)
    v_mov_b32 v48, 0xff800000
    v_mov_b32 v49, 0xff800000
    v_mov_b32 v50, 0xff800000
    v_mov_b32 v51, 0xff800000
    s_mov_b32 s71, 0
L_slow_loop:
    buffer_load_dwordx4 v[160:163], v235, s[40:43], s71 offen offset:0 sc1
    buffer_load_dwordx4 v[164:167], v235, s[40:43], s71 offen offset:1024 sc1
    s_waitcnt vmcnt(0)
    v_mfma_f32_32x32x16_bf16 v[16:31], v[160:163], v[128:131], 0
    v_mfma_f32_32x32x16_bf16 v[16:31], v[164:167], v[132:135], v[16:31]
    s_nop 7
    s_nop 7
    v_max3_f32 v48, v16, v17, v48
    v_max3_f32 v48, v18, v19, v48
    v_max3_f32 v48, v20, v21, v48
    v_max3_f32 v48, v22, v23, v48
    v_max3_f32 v48, v24, v25, v48
    v_max3_f32 v48, v26, v27, v48
    v_max3_f32 v48, v28, v29, v48
    v_max3_f32 v48, v30, v31, v48
    s_nop 7
    v_mfma_f32_32x32x16_bf16 v[16:31], v[160:163], v[136:139], 0
    v_mfma_f32_32x32x16_bf16 v[16:31], v[164:167], v[140:143], v[16:31]
    s_nop 7
    s_nop 7
    v_max3_f32 v49, v16, v17, v49
    v_max3_f32 v49, v18, v19, v49
    v_max3_f32 v49, v20, v21, v49
    v_max3_f32 v49, v22, v23, v49
    v_max3_f32 v49, v24, v25, v49
    v_max3_f32 v49, v26, v27, v49
    v_max3_f32 v49, v28, v29, v49
    v_max3_f32 v49, v30, v31, v49
    s_nop 7
    v_mfma_f32_32x32x16_bf16 v[16:31], v[160:163], v[144:147], 0
    v_mfma_f32_32x32x16_bf16 v[16:31], v[164:167], v[148:151], v[16:31]
    s_nop 7
    s_nop 7
    v_max3_f32 v50, v16, v17, v50
    v_max3_f32 v50, v18, v19, v50
    v_max3_f32 v50, v20, v21, v50
    v_max3_f32 v50, v22, v23, v50
    v_max3_f32 v50, v24, v25, v50
    v_max3_f32 v50, v26, v27, v50
    v_max3_f32 v50, v28, v29, v50
    v_max3_f32 v50, v30, v31, v50
    s_nop 7
    v_mfma_f32_32x32x16_bf16 v[16:31], v[160:163], v[152:155], 0
    v_mfma_f32_32x32x16_bf16 v[16:31], v[164:167], v[156:159], v[16:31]
    s_nop 7
    s_nop 7
    v_max3_f32 v51, v16, v17, v51
    v_max3_f32 v51, v18, v19, v51
    v_max3_f32 v51, v20, v21, v51
    v_max3_f32 v51, v22, v23, v51
    v_max3_f32 v51, v24, v25, v51
    v_max3_f32 v51, v26, v27, v51
    v_max3_f32 v51, v28, v29, v51
    v_max3_f32 v51, v30, v31, v51
    s_nop 7
    s_add_u32 s71, s71, 16384
    s_cmp_lt_u32 s71, 262144
    s_cbranch_scc1 L_slow_loop
    v_mov_b32 v52, v48
    v_mov_b32 v53, v49
    v_mov_b32 v54, v50
    v_mov_b32 v55, v51
    s_nop 1
    v_permlane32_swap_b32 v52, v48
    v_permlane32_swap_b32 v53, v49
    v_permlane32_swap_b32 v54, v50
    v_permlane32_swap_b32 v55, v51
    s_nop 1
    v_max_f32 v48, v52, v48
    v_max_f32 v49, v53, v49
    v_max_f32 v50, v54, v50
    v_max_f32 v51, v55, v51
    s_barrier
    s_lshl_b32 s56, s3, 10
    s_add_u32 s56, s56, 58368
    v_add_u32 v3, s56, v2
    ds_write_b128 v3, v[48:51]
    s_waitcnt lgkmcnt(0)
    s_barrier
    v_add_u32 v3, 58368, v2
    ds_read_b128 v[16:19], v3 offset:0
    ds_read_b128 v[20:23], v3 offset:1024
    ds_read_b128 v[24:27], v3 offset:2048
    ds_read_b128 v[28:31], v3 offset:3072
    s_waitcnt lgkmcnt(0)
    v_max3_f32 v48, v16, v20, v24
    v_max_f32 v48, v48, v28
    v_max3_f32 v49, v17, v21, v25
    v_max_f32 v49, v49, v29
    v_max3_f32 v50, v18, v22, v26
    v_max_f32 v50, v50, v30
    v_max3_f32 v51, v19, v23, v27
    v_max_f32 v51, v51, v31
    s_mov_b32 s56, 0xffff
    v_sub_f32 v16, 0, v48
    v_cvt_pk_bf16_f32 v17, v16, v16
    v_lshlrev_b32 v18, 16, v17
    v_sub_f32 v16, v16, v18
    v_cvt_pk_bf16_f32 v19, v16, v16
    v_lshlrev_b32 v18, 16, v19
    v_sub_f32 v16, v16, v18
    v_bfi_b32 v17, s56, v17, v19
    v_cvt_pk_bf16_f32 v18, v16, 0
    v_cndmask_b32 v134, v134, v17, s[64:65]
    v_cndmask_b32 v135, v135, v18, s[64:65]
    v_sub_f32 v16, 0, v49
    v_cvt_pk_bf16_f32 v17, v16, v16
    v_lshlrev_b32 v18, 16, v17
    v_sub_f32 v16, v16, v18
    v_cvt_pk_bf16_f32 v19, v16, v16
    v_lshlrev_b32 v18, 16, v19
    v_sub_f32 v16, v16, v18
    v_bfi_b32 v17, s56, v17, v19
    v_cvt_pk_bf16_f32 v18, v16, 0
    v_cndmask_b32 v142, v142, v17, s[64:65]
    v_cndmask_b32 v143, v143, v18, s[64:65]
    v_sub_f32 v16, 0, v50
    v_cvt_pk_bf16_f32 v17, v16, v16
    v_lshlrev_b32 v18, 16, v17
    v_sub_f32 v16, v16, v18
    v_cvt_pk_bf16_f32 v19, v16, v16
    v_lshlrev_b32 v18, 16, v19
    v_sub_f32 v16, v16, v18
    v_bfi_b32 v17, s56, v17, v19
    v_cvt_pk_bf16_f32 v18, v16, 0
    v_cndmask_b32 v150, v150, v17, s[64:65]
    v_cndmask_b32 v151, v151, v18, s[64:65]
    v_sub_f32 v16, 0, v51
    v_cvt_pk_bf16_f32 v17, v16, v16
    v_lshlrev_b32 v18, 16, v17
    v_sub_f32 v16, v16, v18
    v_cvt_pk_bf16_f32 v19, v16, v16
    v_lshlrev_b32 v18, 16, v19
    v_sub_f32 v16, v16, v18
    v_bfi_b32 v17, s56, v17, v19
    v_cvt_pk_bf16_f32 v18, v16, 0
    v_cndmask_b32 v158, v158, v17, s[64:65]
    v_cndmask_b32 v159, v159, v18, s[64:65]
    s_mov_b32 s96, 1
    s_lshl_b32 s71, s49, 14
    buffer_load_dwordx4 v[160:163], v235, s[40:43], s71 offen offset:0 sc1
    buffer_load_dwordx4 v[164:167], v235, s[40:43], s71 offen offset:1024 sc1
    buffer_load_dwordx4 v[168:171], v235, s[40:43], s71 offen offset:2048 sc1
    buffer_load_dwordx4 v[172:175], v235, s[40:43], s71 offen offset:3072 sc1
    s_waitcnt vmcnt(0)
    s_barrier
    s_branch L_attn_start
    s_endpgm

.section .rodata,"a"
.p2align 6
.amdhsa_kernel concat_heads__ssm_conv_h3__softmax_full_mha__prompt_kernel
  .amdhsa_next_free_vgpr 256
  .amdhsa_next_free_sgpr 102
  .amdhsa_accum_offset 256
  .amdhsa_group_segment_fixed_size 0
  .amdhsa_kernarg_size 96
  .amdhsa_user_sgpr_count 2
  .amdhsa_user_sgpr_kernarg_segment_ptr 1
  .amdhsa_system_sgpr_workgroup_id_x 1
  .amdhsa_float_denorm_mode_32 3
.end_amdhsa_kernel
```
